```python
import torch

def _softmax(x, axis=-1):
    return torch.softmax(x, dim=axis)
def _gelu(x):
    return torch.nn.functional.gelu(x, approximate="tanh")
def _silu(x):
    return torch.nn.functional.silu(x)
def _sigmoid(x):
    return torch.sigmoid(x)
def _layernorm(x, axis=-1, eps=1e-5):
    m = x.mean(dim=axis, keepdim=True)
    v = x.var(dim=axis, keepdim=True, unbiased=False)
    return (x - m) / torch.sqrt(v + eps)
def _scatter_add(tgt, idx, src, axis=0):
    return tgt.clone().index_add_(axis, idx, src)
def _segment_sum(src, seg, n):
    out = torch.zeros((n,) + src.shape[1:], dtype=src.dtype)
    return out.index_add_(0, seg, src)
def _pad(x, pw):
    flat = tuple(v for pair in reversed(pw) for v in pair)
    return torch.nn.functional.pad(x, flat)

kernel_name = 'standalone__weight_only_int_quip_2__prompt'

def setup_inputs():

    _w = (lambda a: (lambda t: t.to(torch.bfloat16) if t.is_floating_point() else t)(torch.as_tensor(a)))
    B, S, D, F = 1, 2048, 576, 4608
    nbits = max(2, min(4, int(2)))
    G = -1 if -1 > 0 else D
    D = (D // G) * G
    ng = D // G
    qmax = 1 << nbits
    qw = torch.randint(0, qmax, (D, F)).to(torch.int32)
    zp = torch.randint(0, qmax, (ng, F)).to(float)
    sc = torch.abs((lambda *s: torch.randn(*s, dtype=torch.bfloat16) * 0.05)(ng, F)).to(float) * 0.1 + 0.02
    return {
        "x": _w((lambda *s: torch.randn(*s, dtype=torch.bfloat16) * 0.05)(B, S, D)),
        "qw": _w(qw),
        "scales": _w(sc),
        "zeros": _w(zp),
    }

def reference(x, qw, scales, zeros):
    B, S, D = x.shape
    ng, F = scales.shape
    G = D // ng
    s = (lambda x, n, axis: torch.repeat_interleave(x, n, dim=axis))(scales, G, axis=0)
    z = (lambda x, n, axis: torch.repeat_interleave(x, n, dim=axis))(zeros, G, axis=0)
    w = ((lambda x, dt: x.to(dt))(qw, x.dtype) - z) * s
    return torch.einsum("bsd,df->bsf", x, w)
```

```asm
; @launch grid=(256,1,1) block=(512,1,1) lds=136320
.amdgcn_target "amdgcn-amd-amdhsa--gfx950"
.text
.globl standalone__weight_only_int_quip_2__prompt_kernel
.p2align 8
.type standalone__weight_only_int_quip_2__prompt_kernel,@function
standalone__weight_only_int_quip_2__prompt_kernel:
    s_cmp_ge_u32 s2, 256
    s_cbranch_scc1 L_done
    s_load_dwordx4 s[4:7], s[0:1], 0
    s_load_dwordx4 s[8:11], s[0:1], 16
    s_load_dwordx2 s[12:13], s[0:1], 32
    v_and_b32 v1, 63, v0
    s_getpc_b64 s[40:41]
L_pc:
    s_lshr_b32 s42, s2, 3
    s_lshl_b32 s42, s42, 11
    v_lshl_add_u32 v2, v0, 2, s42
    v_min_u32 v2, L_done-L_pc, v2
    v_add_co_u32 v2, vcc, s40, v2
    v_mov_b32 v3, s41
    s_nop 0
    v_addc_co_u32 v3, vcc, 0, v3, vcc
    global_load_dword v4, v[2:3], off
    v_lshrrev_b32 v0, 6, v0
    s_and_b32 s39, s2, 7
    v_readfirstlane_b32 s36, v0
    s_lshr_b32 s40, s2, 3
    s_and_b32 s38, s40, 3
    s_lshr_b32 s37, s40, 2
    s_mul_i32 s42, s39, 576
    s_lshl_b32 s43, s38, 7
    s_add_u32 s45, s42, s43
    s_lshl_b32 s43, s38, 4
    s_add_u32 s46, s42, s43
    s_add_u32 s46, s46, 512
    s_and_b32 s47, s36, 3
    s_mul_i32 s40, s37, 11
    s_lshr_b32 s40, s40, 5
    s_mul_i32 s40, s40, 3
    s_sub_u32 s40, s37, s40
    s_mul_i32 s44, s40, 3
    s_add_u32 s44, s44, s39
    s_cmp_ge_u32 s44, 9
    s_cselect_b32 s40, 9, 0
    s_sub_u32 s44, s44, s40
    s_cmp_ge_u32 s36, 4
    s_cbranch_scc0 L_consumer
    s_mov_b32 s86, s44
    s_lshl_b32 s40, s47, 4
    v_lshrrev_b32 v2, 4, v1
    v_lshl_add_u32 v2, v2, 2, s40
    v_mul_u32_u24 v2, 18432, v2
    v_and_b32 v3, 15, v1
    v_lshl_add_u32 v2, v3, 4, v2
    s_lshl_b32 s41, s45, 2
    v_add_u32 v108, s41, v2
    v_add_u32 v109, 18432, v108
    v_add_u32 v110, 36864, v108
    v_add_u32 v111, 55296, v108
    s_mul_i32 s48, s86, 1179648
    s_add_u32 s86, s86, 1
    s_cmp_eq_u32 s86, 9
    s_cselect_b32 s86, 0, s86
    s_waitcnt lgkmcnt(0)
    s_mov_b32 s20, s6
    s_mov_b32 s21, s7
    s_mov_b32 s22, 10616832
    s_mov_b32 s23, 0x20000
    buffer_load_dwordx4 v[16:19], v108, s[20:23], s48 offen
    v_lshrrev_b32 v2, 3, v1
    buffer_load_dwordx4 v[20:23], v109, s[20:23], s48 offen
    v_lshl_add_u32 v2, v2, 1, s40
    buffer_load_dwordx4 v[24:27], v110, s[20:23], s48 offen
    v_mul_u32_u24 v2, 18432, v2
    buffer_load_dwordx4 v[28:31], v111, s[20:23], s48 offen
    v_and_b32 v3, 7, v1
    buffer_load_dwordx4 v[32:35], v108, s[20:23], s48 offen offset:256
    v_lshl_add_u32 v2, v3, 3, v2
    buffer_load_dwordx4 v[36:39], v109, s[20:23], s48 offen offset:256
    s_lshl_b32 s41, s46, 2
    buffer_load_dwordx4 v[40:43], v110, s[20:23], s48 offen offset:256
    v_add_u32 v84, s41, v2
    buffer_load_dwordx4 v[44:47], v111, s[20:23], s48 offen offset:256
    v_add_u32 v85, 18432, v84
    buffer_load_dwordx2 v[48:49], v84, s[20:23], s48 offen
    buffer_load_dwordx2 v[50:51], v85, s[20:23], s48 offen
    s_branch L_producer2
L_consumer:
    s_lshl_b32 s40, s47, 6
    s_add_u32 s40, s40, s45
    s_cmp_ge_u32 s47, 2
    s_cselect_b32 s40, s46, s40
    s_cselect_b32 s41, 15, 63
    v_and_b32 v3, s41, v1
    v_add_u32 v2, s40, v3
    v_lshlrev_b32 v2, 1, v2
    s_min_u32 s41, s47, 2
    s_lshl_b32 s41, s41, 9
    s_add_u32 s41, s41, 135168
    v_lshlrev_b32 v3, 3, v3
    v_add_u32 v3, s41, v3
    s_lshl_b32 s40, s37, 8
    s_lshl_b32 s41, s47, 6
    s_add_u32 s40, s40, s41
    v_lshrrev_b32 v7, 3, v1
    v_add_u32 v7, s40, v7
    v_mul_u32_u24 v7, 1152, v7
    v_lshrrev_b32 v8, 4, v1
    v_and_b32 v9, 7, v1
    v_xor_b32 v8, v8, v9
    v_lshl_add_u32 v245, v8, 4, v7
    v_xor_b32 v8, 4, v8
    v_lshl_add_u32 v246, v8, 4, v7
    v_add_u32 v247, 16384, v245
    v_add_u32 v248, 24576, v246
    v_add_u32 v246, 8192, v246
    s_lshl_b32 s98, s47, 13
    s_lshl_b32 s94, s44, 7
    s_add_u32 s95, s94, 36864
    s_add_u32 s44, s44, 1
    s_cmp_eq_u32 s44, 9
    s_cselect_b32 s44, 0, s44
    s_lshl_b32 s96, s44, 7
    s_add_u32 s97, s96, 36864
    s_add_u32 s44, s44, 1
    s_cmp_eq_u32 s44, 9
    s_cselect_b32 s44, 0, s44
    s_waitcnt lgkmcnt(0)
    s_mov_b32 s28, s8
    s_mov_b32 s29, s9
    s_mov_b32 s30, 9216
    s_mov_b32 s31, 0x20000
    s_mov_b32 s32, s10
    s_mov_b32 s33, s11
    s_mov_b32 s34, 9216
    s_mov_b32 s35, 0x20000
    s_mov_b32 s16, s4
    s_mov_b32 s17, s5
    s_mov_b32 s18, 2359296
    s_mov_b32 s19, 0x20000
    buffer_load_ushort v5, v2, s[28:31], 0 offen
    buffer_load_ushort v6, v2, s[32:35], 0 offen
    s_add_u32 m0, s98, 0
    s_nop 0
    buffer_load_dwordx4 v245, s[16:19], s94 offen lds
    buffer_load_dwordx4 v246, s[16:19], s94 offen offset:1024 lds
    buffer_load_dwordx4 v247, s[16:19], s94 offen offset:2048 lds
    buffer_load_dwordx4 v248, s[16:19], s94 offen offset:3072 lds
    s_add_u32 m0, s98, 4096
    s_nop 0
    buffer_load_dwordx4 v245, s[16:19], s95 offen lds
    buffer_load_dwordx4 v246, s[16:19], s95 offen offset:1024 lds
    buffer_load_dwordx4 v247, s[16:19], s95 offen offset:2048 lds
    buffer_load_dwordx4 v248, s[16:19], s95 offen offset:3072 lds
    s_waitcnt vmcnt(8)
    v_lshlrev_b32 v6, 16, v6
    v_lshlrev_b32 v5, 16, v5
    v_sub_f32 v8, 0, v6
    v_sub_f32 v9, 1.0, v6
    v_sub_f32 v10, 2.0, v6
    v_sub_f32 v11, 0x40400000, v6
    v_cvt_pk_bf16_f32 v8, v8, v9
    v_cvt_pk_bf16_f32 v10, v10, v11
    v_and_b32 v9, 0xffff0000, v8
    v_lshlrev_b32 v8, 16, v8
    v_and_b32 v11, 0xffff0000, v10
    v_lshlrev_b32 v10, 16, v10
    v_mul_f32 v8, v8, v5
    v_mul_f32 v9, v9, v5
    v_mul_f32 v10, v10, v5
    v_mul_f32 v11, v11, v5
    v_cvt_pk_bf16_f32 v8, v8, v9
    v_cvt_pk_bf16_f32 v9, v10, v11
    s_mov_b32 s92, 0x06040200
    s_mov_b32 s93, 0x07050301
    v_perm_b32 v10, v9, v8, s92
    v_perm_b32 v11, v9, v8, s93
    ds_write_b64 v3, v[10:11]
    s_waitcnt lgkmcnt(0)
    s_barrier
    s_add_u32 m0, s98, 32768
    s_nop 0
    buffer_load_dwordx4 v245, s[16:19], s96 offen lds
    buffer_load_dwordx4 v246, s[16:19], s96 offen offset:1024 lds
    buffer_load_dwordx4 v247, s[16:19], s96 offen offset:2048 lds
    buffer_load_dwordx4 v248, s[16:19], s96 offen offset:3072 lds
    s_add_u32 m0, s98, 36864
    s_nop 0
    buffer_load_dwordx4 v245, s[16:19], s97 offen lds
    buffer_load_dwordx4 v246, s[16:19], s97 offen offset:1024 lds
    buffer_load_dwordx4 v247, s[16:19], s97 offen offset:2048 lds
    buffer_load_dwordx4 v248, s[16:19], s97 offen offset:3072 lds
    s_lshl_b32 s64, s44, 7
    s_add_u32 s65, s64, 36864
    s_add_u32 s44, s44, 1
    s_cmp_eq_u32 s44, 9
    s_cselect_b32 s44, 0, s44
    s_lshl_b32 s66, s44, 7
    s_add_u32 s67, s66, 36864
    s_add_u32 s44, s44, 1
    s_cmp_eq_u32 s44, 9
    s_cselect_b32 s44, 0, s44
    s_lshl_b32 s68, s44, 7
    s_add_u32 s69, s68, 36864
    s_add_u32 s44, s44, 1
    s_cmp_eq_u32 s44, 9
    s_cselect_b32 s44, 0, s44
    s_lshl_b32 s70, s44, 7
    s_add_u32 s71, s70, 36864
    s_add_u32 s44, s44, 1
    s_cmp_eq_u32 s44, 9
    s_cselect_b32 s44, 0, s44
    s_lshl_b32 s72, s44, 7
    s_add_u32 s73, s72, 36864
    s_add_u32 s44, s44, 1
    s_cmp_eq_u32 s44, 9
    s_cselect_b32 s44, 0, s44
    s_lshl_b32 s74, s44, 7
    s_add_u32 s75, s74, 36864
    s_add_u32 s44, s44, 1
    s_cmp_eq_u32 s44, 9
    s_cselect_b32 s44, 0, s44
    s_lshl_b32 s76, s44, 7
    s_add_u32 s77, s76, 36864
    s_add_u32 s44, s44, 1
    s_cmp_eq_u32 s44, 9
    s_cselect_b32 s44, 0, s44
    s_setprio 3
    s_mov_b32 s24, s12
    s_mov_b32 s25, s13
    s_mov_b32 s26, 18874368
    s_mov_b32 s27, 0x20000
    s_lshl_b32 s40, s47, 13
    v_and_b32 v11, 15, v1
    v_lshlrev_b32 v8, 7, v11
    v_add_u32 v8, s40, v8
    v_bfe_u32 v9, v1, 1, 3
    v_lshrrev_b32 v12, 4, v1
    v_xor_b32 v9, v9, v12
    v_lshl_add_u32 v228, v9, 4, v8
    v_xor_b32 v229, 64, v228
    v_add_u32 v230, 65536, v228
    v_add_u32 v231, 65536, v229
    v_lshlrev_b32 v8, 4, v1
    v_add_u32 v232, 98304, v8
    s_lshl_b32 s40, s37, 8
    s_lshl_b32 s41, s47, 6
    s_add_u32 s41, s41, s40
    s_mul_i32 s41, s41, 9216
    s_lshl_b32 s42, s45, 1
    s_add_u32 s42, s41, s42
    v_mul_u32_u24 v8, 36864, v12
    v_lshl_add_u32 v8, v11, 3, v8
    v_add_u32 v233, s42, v8
    s_lshl_b32 s42, s46, 1
    s_add_u32 s42, s41, s42
    v_mul_u32_u24 v8, 9216, v11
    v_lshl_add_u32 v8, v12, 3, v8
    v_add_u32 v234, s42, v8
    s_mov_b32 s48, 0
    s_mov_b32 s49, 9216
    s_mov_b32 s50, 18432
    s_mov_b32 s51, 27648
    s_mov_b32 s52, 147456
    s_mov_b32 s53, 156672
    s_mov_b32 s54, 165888
    s_mov_b32 s55, 175104
    s_mov_b32 s56, 294912
    s_mov_b32 s57, 304128
    s_mov_b32 s58, 313344
    s_mov_b32 s59, 322560
    s_mov_b32 s60, 442368
    s_mov_b32 s61, 451584
    s_mov_b32 s62, 460800
    s_mov_b32 s63, 470016
    s_branch L_consumer2
L_producer2:
    s_mov_b32 s84, 0x04040000
    v_mov_b32 v114, 0x04000400
    s_lshr_b32 s40, s47, 1
    s_lshl_b32 s40, s40, 12
    s_and_b32 s41, s47, 1
    s_lshl_b32 s41, s41, 9
    s_add_u32 s40, s40, s41
    s_add_u32 s40, s40, 98304
    v_and_b32 v2, 15, v1
    v_lshrrev_b32 v3, 5, v1
    v_lshl_add_u32 v2, v3, 4, v2
    v_lshlrev_b32 v2, 4, v2
    v_bfe_u32 v3, v1, 4, 1
    v_lshl_add_u32 v2, v3, 11, v2
    v_add_u32 v112, s40, v2
    s_lshr_b32 s40, s47, 1
    s_lshl_b32 s40, s40, 10
    s_and_b32 s41, s47, 1
    s_lshl_b32 s41, s41, 9
    s_add_u32 s40, s40, s41
    s_add_u32 s40, s40, 114688
    v_and_b32 v2, 7, v1
    v_lshlrev_b32 v2, 5, v2
    v_lshrrev_b32 v3, 5, v1
    v_lshl_add_u32 v2, v3, 8, v2
    v_bfe_u32 v3, v1, 3, 2
    v_lshl_add_u32 v2, v3, 2, v2
    v_add_u32 v113, s40, v2
    v_and_b32 v2, 15, v1
    v_lshlrev_b32 v2, 5, v2
    v_add_u32 v115, 135168, v2
    v_and_b32 v2, 7, v1
    v_lshlrev_b32 v2, 4, v2
    v_add_u32 v5, 136192, v2
    s_mul_i32 s49, s86, 1179648
    s_add_u32 s86, s86, 1
    s_cmp_eq_u32 s86, 9
    s_cselect_b32 s86, 0, s86
    s_mul_i32 s50, s86, 1179648
    s_add_u32 s86, s86, 1
    s_cmp_eq_u32 s86, 9
    s_cselect_b32 s86, 0, s86
    s_barrier
    ds_read_b128 v[64:67], v115 offset:0
    ds_read_b128 v[68:71], v115 offset:16
    ds_read_b128 v[72:75], v115 offset:512
    ds_read_b128 v[76:79], v115 offset:528
    ds_read_b128 v[80:83], v5
    buffer_load_dwordx4 v[116:119], v108, s[20:23], s49 offen
    s_waitcnt vmcnt(9)
    v_perm_b32 v16, v20, v16, s84
    s_waitcnt vmcnt(7)
    v_perm_b32 v24, v28, v24, s84
    v_perm_b32 v18, v22, v18, s84
    v_perm_b32 v26, v30, v26, s84
    v_perm_b32 v17, v21, v17, s84
    v_perm_b32 v25, v29, v25, s84
    buffer_load_dwordx4 v[120:123], v109, s[20:23], s49 offen
    v_perm_b32 v19, v23, v19, s84
    v_perm_b32 v27, v31, v27, s84
    v_or_b32 v16, v114, v16
    v_or_b32 v24, v114, v24
    v_or_b32 v18, v114, v18
    v_or_b32 v26, v114, v26
    v_or_b32 v17, v114, v17
    buffer_load_dwordx4 v[124:127], v110, s[20:23], s49 offen
    v_or_b32 v25, v114, v25
    v_or_b32 v19, v114, v19
    v_or_b32 v27, v114, v27
    s_waitcnt lgkmcnt(4)
    v_perm_b32 v88, v65, v64, v16
    v_perm_b32 v89, v65, v64, v24
    s_waitcnt lgkmcnt(3)
    v_perm_b32 v90, v69, v68, v18
    v_perm_b32 v91, v69, v68, v26
    buffer_load_dwordx4 v[128:131], v111, s[20:23], s49 offen
    v_perm_b32 v92, v67, v66, v17
    v_perm_b32 v93, v67, v66, v25
    v_perm_b32 v94, v71, v70, v19
    v_perm_b32 v95, v71, v70, v27
    v_permlane16_swap_b32 v88, v90
    v_permlane16_swap_b32 v89, v91
    buffer_load_dwordx4 v[132:135], v108, s[20:23], s49 offen offset:256
    v_permlane16_swap_b32 v92, v94
    v_permlane16_swap_b32 v93, v95
    ds_write_b128 v112, v[88:91] offset:0
    ds_write_b128 v112, v[92:95] offset:1024
    s_mul_i32 s51, s86, 1179648
    s_add_u32 s86, s86, 1
    s_cmp_eq_u32 s86, 9
    s_cselect_b32 s86, 0, s86
    buffer_load_dwordx4 v[136:139], v109, s[20:23], s49 offen offset:256
    s_waitcnt vmcnt(10)
    v_perm_b32 v32, v36, v32, s84
    s_waitcnt vmcnt(8)
    v_perm_b32 v40, v44, v40, s84
    v_perm_b32 v34, v38, v34, s84
    v_perm_b32 v42, v46, v42, s84
    v_perm_b32 v33, v37, v33, s84
    v_perm_b32 v41, v45, v41, s84
    v_perm_b32 v35, v39, v35, s84
    buffer_load_dwordx4 v[140:143], v110, s[20:23], s49 offen offset:256
    v_perm_b32 v43, v47, v43, s84
    v_or_b32 v32, v114, v32
    v_or_b32 v40, v114, v40
    v_or_b32 v34, v114, v34
    v_or_b32 v42, v114, v42
    v_or_b32 v33, v114, v33
    buffer_load_dwordx4 v[144:147], v111, s[20:23], s49 offen offset:256
    v_or_b32 v41, v114, v41
    v_or_b32 v35, v114, v35
    v_or_b32 v43, v114, v43
    s_waitcnt lgkmcnt(4)
    v_perm_b32 v96, v73, v72, v32
    v_perm_b32 v97, v73, v72, v40
    s_waitcnt lgkmcnt(3)
    v_perm_b32 v98, v77, v76, v34
    v_perm_b32 v99, v77, v76, v42
    buffer_load_dwordx2 v[148:149], v84, s[20:23], s49 offen
    v_perm_b32 v100, v75, v74, v33
    v_perm_b32 v101, v75, v74, v41
    v_perm_b32 v102, v79, v78, v35
    v_perm_b32 v103, v79, v78, v43
    v_permlane16_swap_b32 v96, v98
    v_permlane16_swap_b32 v97, v99
    v_permlane16_swap_b32 v100, v102
    buffer_load_dwordx2 v[150:151], v85, s[20:23], s49 offen
    v_permlane16_swap_b32 v101, v103
    ds_write_b128 v112, v[96:99] offset:8192
    ds_write_b128 v112, v[100:103] offset:9216
    s_waitcnt vmcnt(10)
    v_perm_b32 v48, v50, v48, s84
    v_perm_b32 v49, v51, v49, s84
    v_or_b32 v48, v114, v48
    v_or_b32 v49, v114, v49
    s_waitcnt lgkmcnt(4)
    v_perm_b32 v104, v81, v80, v48
    v_perm_b32 v105, v83, v82, v49
    ds_write_b32 v113, v104 offset:0
    ds_write_b32 v113, v105 offset:16
    s_waitcnt lgkmcnt(0)
    s_barrier
    buffer_load_dwordx4 v[16:19], v108, s[20:23], s50 offen
    s_waitcnt vmcnt(9)
    v_perm_b32 v116, v120, v116, s84
    s_waitcnt vmcnt(7)
    v_perm_b32 v124, v128, v124, s84
    v_perm_b32 v118, v122, v118, s84
    v_perm_b32 v126, v130, v126, s84
    v_perm_b32 v117, v121, v117, s84
    v_perm_b32 v125, v129, v125, s84
    buffer_load_dwordx4 v[20:23], v109, s[20:23], s50 offen
    v_perm_b32 v119, v123, v119, s84
    v_perm_b32 v127, v131, v127, s84
    v_or_b32 v116, v114, v116
    v_or_b32 v124, v114, v124
    v_or_b32 v118, v114, v118
    v_or_b32 v126, v114, v126
    v_or_b32 v117, v114, v117
    buffer_load_dwordx4 v[24:27], v110, s[20:23], s50 offen
    v_or_b32 v125, v114, v125
    v_or_b32 v119, v114, v119
    v_or_b32 v127, v114, v127
    v_perm_b32 v88, v65, v64, v116
    v_perm_b32 v89, v65, v64, v124
    v_perm_b32 v90, v69, v68, v118
    v_perm_b32 v91, v69, v68, v126
    buffer_load_dwordx4 v[28:31], v111, s[20:23], s50 offen
    v_perm_b32 v92, v67, v66, v117
    v_perm_b32 v93, v67, v66, v125
    v_perm_b32 v94, v71, v70, v119
    v_perm_b32 v95, v71, v70, v127
    v_permlane16_swap_b32 v88, v90
    v_permlane16_swap_b32 v89, v91
    buffer_load_dwordx4 v[32:35], v108, s[20:23], s50 offen offset:256
    v_permlane16_swap_b32 v92, v94
    v_permlane16_swap_b32 v93, v95
    ds_write_b128 v112, v[88:91] offset:18432
    ds_write_b128 v112, v[92:95] offset:19456
    s_mul_i32 s52, s86, 1179648
    s_add_u32 s86, s86, 1
    s_cmp_eq_u32 s86, 9
    s_cselect_b32 s86, 0, s86
    buffer_load_dwordx4 v[36:39], v109, s[20:23], s50 offen offset:256
    s_waitcnt vmcnt(10)
    v_perm_b32 v132, v136, v132, s84
    s_waitcnt vmcnt(8)
    v_perm_b32 v140, v144, v140, s84
    v_perm_b32 v134, v138, v134, s84
    v_perm_b32 v142, v146, v142, s84
    v_perm_b32 v133, v137, v133, s84
    v_perm_b32 v141, v145, v141, s84
    v_perm_b32 v135, v139, v135, s84
    buffer_load_dwordx4 v[40:43], v110, s[20:23], s50 offen offset:256
    v_perm_b32 v143, v147, v143, s84
    v_or_b32 v132, v114, v132
    v_or_b32 v140, v114, v140
    v_or_b32 v134, v114, v134
    v_or_b32 v142, v114, v142
    v_or_b32 v133, v114, v133
    buffer_load_dwordx4 v[44:47], v111, s[20:23], s50 offen offset:256
    v_or_b32 v141, v114, v141
    v_or_b32 v135, v114, v135
    v_or_b32 v143, v114, v143
    v_perm_b32 v96, v73, v72, v132
    v_perm_b32 v97, v73, v72, v140
    v_perm_b32 v98, v77, v76, v134
    v_perm_b32 v99, v77, v76, v142
    buffer_load_dwordx2 v[48:49], v84, s[20:23], s50 offen
    v_perm_b32 v100, v75, v74, v133
    v_perm_b32 v101, v75, v74, v141
    v_perm_b32 v102, v79, v78, v135
    v_perm_b32 v103, v79, v78, v143
    v_permlane16_swap_b32 v96, v98
    v_permlane16_swap_b32 v97, v99
    v_permlane16_swap_b32 v100, v102
    buffer_load_dwordx2 v[50:51], v85, s[20:23], s50 offen
    v_permlane16_swap_b32 v101, v103
    ds_write_b128 v112, v[96:99] offset:26624
    ds_write_b128 v112, v[100:103] offset:27648
    s_waitcnt vmcnt(10)
    v_perm_b32 v148, v150, v148, s84
    v_perm_b32 v149, v151, v149, s84
    v_or_b32 v148, v114, v148
    v_or_b32 v149, v114, v149
    v_perm_b32 v104, v81, v80, v148
    v_perm_b32 v105, v83, v82, v149
    ds_write_b32 v113, v104 offset:18432
    ds_write_b32 v113, v105 offset:18448
    s_waitcnt lgkmcnt(0)
    s_barrier
    buffer_load_dwordx4 v[116:119], v108, s[20:23], s51 offen
    s_waitcnt vmcnt(9)
    v_perm_b32 v16, v20, v16, s84
    s_waitcnt vmcnt(7)
    v_perm_b32 v24, v28, v24, s84
    v_perm_b32 v18, v22, v18, s84
    v_perm_b32 v26, v30, v26, s84
    v_perm_b32 v17, v21, v17, s84
    v_perm_b32 v25, v29, v25, s84
    buffer_load_dwordx4 v[120:123], v109, s[20:23], s51 offen
    v_perm_b32 v19, v23, v19, s84
    v_perm_b32 v27, v31, v27, s84
    v_or_b32 v16, v114, v16
    v_or_b32 v24, v114, v24
    v_or_b32 v18, v114, v18
    v_or_b32 v26, v114, v26
    v_or_b32 v17, v114, v17
    buffer_load_dwordx4 v[124:127], v110, s[20:23], s51 offen
    v_or_b32 v25, v114, v25
    v_or_b32 v19, v114, v19
    v_or_b32 v27, v114, v27
    v_perm_b32 v88, v65, v64, v16
    v_perm_b32 v89, v65, v64, v24
    v_perm_b32 v90, v69, v68, v18
    v_perm_b32 v91, v69, v68, v26
    buffer_load_dwordx4 v[128:131], v111, s[20:23], s51 offen
    v_perm_b32 v92, v67, v66, v17
    v_perm_b32 v93, v67, v66, v25
    v_perm_b32 v94, v71, v70, v19
    v_perm_b32 v95, v71, v70, v27
    v_permlane16_swap_b32 v88, v90
    v_permlane16_swap_b32 v89, v91
    buffer_load_dwordx4 v[132:135], v108, s[20:23], s51 offen offset:256
    v_permlane16_swap_b32 v92, v94
    v_permlane16_swap_b32 v93, v95
    ds_write_b128 v112, v[88:91] offset:0
    ds_write_b128 v112, v[92:95] offset:1024
    s_mul_i32 s53, s86, 1179648
    s_add_u32 s86, s86, 1
    s_cmp_eq_u32 s86, 9
    s_cselect_b32 s86, 0, s86
    buffer_load_dwordx4 v[136:139], v109, s[20:23], s51 offen offset:256
    s_waitcnt vmcnt(10)
    v_perm_b32 v32, v36, v32, s84
    s_waitcnt vmcnt(8)
    v_perm_b32 v40, v44, v40, s84
    v_perm_b32 v34, v38, v34, s84
    v_perm_b32 v42, v46, v42, s84
    v_perm_b32 v33, v37, v33, s84
    v_perm_b32 v41, v45, v41, s84
    v_perm_b32 v35, v39, v35, s84
    buffer_load_dwordx4 v[140:143], v110, s[20:23], s51 offen offset:256
    v_perm_b32 v43, v47, v43, s84
    v_or_b32 v32, v114, v32
    v_or_b32 v40, v114, v40
    v_or_b32 v34, v114, v34
    v_or_b32 v42, v114, v42
    v_or_b32 v33, v114, v33
    buffer_load_dwordx4 v[144:147], v111, s[20:23], s51 offen offset:256
    v_or_b32 v41, v114, v41
    v_or_b32 v35, v114, v35
    v_or_b32 v43, v114, v43
    v_perm_b32 v96, v73, v72, v32
    v_perm_b32 v97, v73, v72, v40
    v_perm_b32 v98, v77, v76, v34
    v_perm_b32 v99, v77, v76, v42
    buffer_load_dwordx2 v[148:149], v84, s[20:23], s51 offen
    v_perm_b32 v100, v75, v74, v33
    v_perm_b32 v101, v75, v74, v41
    v_perm_b32 v102, v79, v78, v35
    v_perm_b32 v103, v79, v78, v43
    v_permlane16_swap_b32 v96, v98
    v_permlane16_swap_b32 v97, v99
    v_permlane16_swap_b32 v100, v102
    buffer_load_dwordx2 v[150:151], v85, s[20:23], s51 offen
    v_permlane16_swap_b32 v101, v103
    ds_write_b128 v112, v[96:99] offset:8192
    ds_write_b128 v112, v[100:103] offset:9216
    s_waitcnt vmcnt(10)
    v_perm_b32 v48, v50, v48, s84
    v_perm_b32 v49, v51, v49, s84
    v_or_b32 v48, v114, v48
    v_or_b32 v49, v114, v49
    v_perm_b32 v104, v81, v80, v48
    v_perm_b32 v105, v83, v82, v49
    ds_write_b32 v113, v104 offset:0
    ds_write_b32 v113, v105 offset:16
    s_waitcnt lgkmcnt(0)
    s_barrier
    buffer_load_dwordx4 v[16:19], v108, s[20:23], s52 offen
    s_waitcnt vmcnt(9)
    v_perm_b32 v116, v120, v116, s84
    s_waitcnt vmcnt(7)
    v_perm_b32 v124, v128, v124, s84
    v_perm_b32 v118, v122, v118, s84
    v_perm_b32 v126, v130, v126, s84
    v_perm_b32 v117, v121, v117, s84
    v_perm_b32 v125, v129, v125, s84
    buffer_load_dwordx4 v[20:23], v109, s[20:23], s52 offen
    v_perm_b32 v119, v123, v119, s84
    v_perm_b32 v127, v131, v127, s84
    v_or_b32 v116, v114, v116
    v_or_b32 v124, v114, v124
    v_or_b32 v118, v114, v118
    v_or_b32 v126, v114, v126
    v_or_b32 v117, v114, v117
    buffer_load_dwordx4 v[24:27], v110, s[20:23], s52 offen
    v_or_b32 v125, v114, v125
    v_or_b32 v119, v114, v119
    v_or_b32 v127, v114, v127
    v_perm_b32 v88, v65, v64, v116
    v_perm_b32 v89, v65, v64, v124
    v_perm_b32 v90, v69, v68, v118
    v_perm_b32 v91, v69, v68, v126
    buffer_load_dwordx4 v[28:31], v111, s[20:23], s52 offen
    v_perm_b32 v92, v67, v66, v117
    v_perm_b32 v93, v67, v66, v125
    v_perm_b32 v94, v71, v70, v119
    v_perm_b32 v95, v71, v70, v127
    v_permlane16_swap_b32 v88, v90
    v_permlane16_swap_b32 v89, v91
    buffer_load_dwordx4 v[32:35], v108, s[20:23], s52 offen offset:256
    v_permlane16_swap_b32 v92, v94
    v_permlane16_swap_b32 v93, v95
    ds_write_b128 v112, v[88:91] offset:18432
    ds_write_b128 v112, v[92:95] offset:19456
    s_mul_i32 s54, s86, 1179648
    s_add_u32 s86, s86, 1
    s_cmp_eq_u32 s86, 9
    s_cselect_b32 s86, 0, s86
    buffer_load_dwordx4 v[36:39], v109, s[20:23], s52 offen offset:256
    s_waitcnt vmcnt(10)
    v_perm_b32 v132, v136, v132, s84
    s_waitcnt vmcnt(8)
    v_perm_b32 v140, v144, v140, s84
    v_perm_b32 v134, v138, v134, s84
    v_perm_b32 v142, v146, v142, s84
    v_perm_b32 v133, v137, v133, s84
    v_perm_b32 v141, v145, v141, s84
    v_perm_b32 v135, v139, v135, s84
    buffer_load_dwordx4 v[40:43], v110, s[20:23], s52 offen offset:256
    v_perm_b32 v143, v147, v143, s84
    v_or_b32 v132, v114, v132
    v_or_b32 v140, v114, v140
    v_or_b32 v134, v114, v134
    v_or_b32 v142, v114, v142
    v_or_b32 v133, v114, v133
    buffer_load_dwordx4 v[44:47], v111, s[20:23], s52 offen offset:256
    v_or_b32 v141, v114, v141
    v_or_b32 v135, v114, v135
    v_or_b32 v143, v114, v143
    v_perm_b32 v96, v73, v72, v132
    v_perm_b32 v97, v73, v72, v140
    v_perm_b32 v98, v77, v76, v134
    v_perm_b32 v99, v77, v76, v142
    buffer_load_dwordx2 v[48:49], v84, s[20:23], s52 offen
    v_perm_b32 v100, v75, v74, v133
    v_perm_b32 v101, v75, v74, v141
    v_perm_b32 v102, v79, v78, v135
    v_perm_b32 v103, v79, v78, v143
    v_permlane16_swap_b32 v96, v98
    v_permlane16_swap_b32 v97, v99
    v_permlane16_swap_b32 v100, v102
    buffer_load_dwordx2 v[50:51], v85, s[20:23], s52 offen
    v_permlane16_swap_b32 v101, v103
    ds_write_b128 v112, v[96:99] offset:26624
    ds_write_b128 v112, v[100:103] offset:27648
    s_waitcnt vmcnt(10)
    v_perm_b32 v148, v150, v148, s84
    v_perm_b32 v149, v151, v149, s84
    v_or_b32 v148, v114, v148
    v_or_b32 v149, v114, v149
    v_perm_b32 v104, v81, v80, v148
    v_perm_b32 v105, v83, v82, v149
    ds_write_b32 v113, v104 offset:18432
    ds_write_b32 v113, v105 offset:18448
    s_waitcnt lgkmcnt(0)
    s_barrier
    buffer_load_dwordx4 v[116:119], v108, s[20:23], s53 offen
    s_waitcnt vmcnt(9)
    v_perm_b32 v16, v20, v16, s84
    s_waitcnt vmcnt(7)
    v_perm_b32 v24, v28, v24, s84
    v_perm_b32 v18, v22, v18, s84
    v_perm_b32 v26, v30, v26, s84
    v_perm_b32 v17, v21, v17, s84
    v_perm_b32 v25, v29, v25, s84
    buffer_load_dwordx4 v[120:123], v109, s[20:23], s53 offen
    v_perm_b32 v19, v23, v19, s84
    v_perm_b32 v27, v31, v27, s84
    v_or_b32 v16, v114, v16
    v_or_b32 v24, v114, v24
    v_or_b32 v18, v114, v18
    v_or_b32 v26, v114, v26
    v_or_b32 v17, v114, v17
    buffer_load_dwordx4 v[124:127], v110, s[20:23], s53 offen
    v_or_b32 v25, v114, v25
    v_or_b32 v19, v114, v19
    v_or_b32 v27, v114, v27
    v_perm_b32 v88, v65, v64, v16
    v_perm_b32 v89, v65, v64, v24
    v_perm_b32 v90, v69, v68, v18
    v_perm_b32 v91, v69, v68, v26
    buffer_load_dwordx4 v[128:131], v111, s[20:23], s53 offen
    v_perm_b32 v92, v67, v66, v17
    v_perm_b32 v93, v67, v66, v25
    v_perm_b32 v94, v71, v70, v19
    v_perm_b32 v95, v71, v70, v27
    v_permlane16_swap_b32 v88, v90
    v_permlane16_swap_b32 v89, v91
    buffer_load_dwordx4 v[132:135], v108, s[20:23], s53 offen offset:256
    v_permlane16_swap_b32 v92, v94
    v_permlane16_swap_b32 v93, v95
    ds_write_b128 v112, v[88:91] offset:0
    ds_write_b128 v112, v[92:95] offset:1024
    s_mul_i32 s55, s86, 1179648
    s_add_u32 s86, s86, 1
    s_cmp_eq_u32 s86, 9
    s_cselect_b32 s86, 0, s86
    buffer_load_dwordx4 v[136:139], v109, s[20:23], s53 offen offset:256
    s_waitcnt vmcnt(10)
    v_perm_b32 v32, v36, v32, s84
    s_waitcnt vmcnt(8)
    v_perm_b32 v40, v44, v40, s84
    v_perm_b32 v34, v38, v34, s84
    v_perm_b32 v42, v46, v42, s84
    v_perm_b32 v33, v37, v33, s84
    v_perm_b32 v41, v45, v41, s84
    v_perm_b32 v35, v39, v35, s84
    buffer_load_dwordx4 v[140:143], v110, s[20:23], s53 offen offset:256
    v_perm_b32 v43, v47, v43, s84
    v_or_b32 v32, v114, v32
    v_or_b32 v40, v114, v40
    v_or_b32 v34, v114, v34
    v_or_b32 v42, v114, v42
    v_or_b32 v33, v114, v33
    buffer_load_dwordx4 v[144:147], v111, s[20:23], s53 offen offset:256
    v_or_b32 v41, v114, v41
    v_or_b32 v35, v114, v35
    v_or_b32 v43, v114, v43
    v_perm_b32 v96, v73, v72, v32
    v_perm_b32 v97, v73, v72, v40
    v_perm_b32 v98, v77, v76, v34
    v_perm_b32 v99, v77, v76, v42
    buffer_load_dwordx2 v[148:149], v84, s[20:23], s53 offen
    v_perm_b32 v100, v75, v74, v33
    v_perm_b32 v101, v75, v74, v41
    v_perm_b32 v102, v79, v78, v35
    v_perm_b32 v103, v79, v78, v43
    v_permlane16_swap_b32 v96, v98
    v_permlane16_swap_b32 v97, v99
    v_permlane16_swap_b32 v100, v102
    buffer_load_dwordx2 v[150:151], v85, s[20:23], s53 offen
    v_permlane16_swap_b32 v101, v103
    ds_write_b128 v112, v[96:99] offset:8192
    ds_write_b128 v112, v[100:103] offset:9216
    s_waitcnt vmcnt(10)
    v_perm_b32 v48, v50, v48, s84
    v_perm_b32 v49, v51, v49, s84
    v_or_b32 v48, v114, v48
    v_or_b32 v49, v114, v49
    v_perm_b32 v104, v81, v80, v48
    v_perm_b32 v105, v83, v82, v49
    ds_write_b32 v113, v104 offset:0
    ds_write_b32 v113, v105 offset:16
    s_waitcnt lgkmcnt(0)
    s_barrier
    buffer_load_dwordx4 v[16:19], v108, s[20:23], s54 offen
    s_waitcnt vmcnt(9)
    v_perm_b32 v116, v120, v116, s84
    s_waitcnt vmcnt(7)
    v_perm_b32 v124, v128, v124, s84
    v_perm_b32 v118, v122, v118, s84
    v_perm_b32 v126, v130, v126, s84
    v_perm_b32 v117, v121, v117, s84
    v_perm_b32 v125, v129, v125, s84
    buffer_load_dwordx4 v[20:23], v109, s[20:23], s54 offen
    v_perm_b32 v119, v123, v119, s84
    v_perm_b32 v127, v131, v127, s84
    v_or_b32 v116, v114, v116
    v_or_b32 v124, v114, v124
    v_or_b32 v118, v114, v118
    v_or_b32 v126, v114, v126
    v_or_b32 v117, v114, v117
    buffer_load_dwordx4 v[24:27], v110, s[20:23], s54 offen
    v_or_b32 v125, v114, v125
    v_or_b32 v119, v114, v119
    v_or_b32 v127, v114, v127
    v_perm_b32 v88, v65, v64, v116
    v_perm_b32 v89, v65, v64, v124
    v_perm_b32 v90, v69, v68, v118
    buffer_load_dwordx4 v[28:31], v111, s[20:23], s54 offen
    v_perm_b32 v91, v69, v68, v126
    v_perm_b32 v92, v67, v66, v117
    v_perm_b32 v93, v67, v66, v125
    v_perm_b32 v94, v71, v70, v119
    v_perm_b32 v95, v71, v70, v127
    v_permlane16_swap_b32 v88, v90
    v_permlane16_swap_b32 v89, v91
    buffer_load_dwordx4 v[32:35], v108, s[20:23], s54 offen offset:256
    v_permlane16_swap_b32 v92, v94
    v_permlane16_swap_b32 v93, v95
    ds_write_b128 v112, v[88:91] offset:18432
    ds_write_b128 v112, v[92:95] offset:19456
    s_mul_i32 s56, s86, 1179648
    s_waitcnt vmcnt(9)
    v_perm_b32 v132, v136, v132, s84
    buffer_load_dwordx4 v[36:39], v109, s[20:23], s54 offen offset:256
    s_waitcnt vmcnt(8)
    v_perm_b32 v140, v144, v140, s84
    v_perm_b32 v134, v138, v134, s84
    v_perm_b32 v142, v146, v142, s84
    v_perm_b32 v133, v137, v133, s84
    v_perm_b32 v141, v145, v141, s84
    v_perm_b32 v135, v139, v135, s84
    v_perm_b32 v143, v147, v143, s84
    buffer_load_dwordx4 v[40:43], v110, s[20:23], s54 offen offset:256
    v_or_b32 v132, v114, v132
    v_or_b32 v140, v114, v140
    v_or_b32 v134, v114, v134
    v_or_b32 v142, v114, v142
    v_or_b32 v133, v114, v133
    v_or_b32 v141, v114, v141
    buffer_load_dwordx4 v[44:47], v111, s[20:23], s54 offen offset:256
    v_or_b32 v135, v114, v135
    v_or_b32 v143, v114, v143
    v_perm_b32 v96, v73, v72, v132
    v_perm_b32 v97, v73, v72, v140
    v_perm_b32 v98, v77, v76, v134
    v_perm_b32 v99, v77, v76, v142
    v_perm_b32 v100, v75, v74, v133
    buffer_load_dwordx2 v[48:49], v84, s[20:23], s54 offen
    v_perm_b32 v101, v75, v74, v141
    v_perm_b32 v102, v79, v78, v135
    v_perm_b32 v103, v79, v78, v143
    v_permlane16_swap_b32 v96, v98
    v_permlane16_swap_b32 v97, v99
    v_permlane16_swap_b32 v100, v102
    buffer_load_dwordx2 v[50:51], v85, s[20:23], s54 offen
    v_permlane16_swap_b32 v101, v103
    ds_write_b128 v112, v[96:99] offset:26624
    ds_write_b128 v112, v[100:103] offset:27648
    s_waitcnt vmcnt(10)
    v_perm_b32 v148, v150, v148, s84
    v_perm_b32 v149, v151, v149, s84
    v_or_b32 v148, v114, v148
    v_or_b32 v149, v114, v149
    v_perm_b32 v104, v81, v80, v148
    v_perm_b32 v105, v83, v82, v149
    ds_write_b32 v113, v104 offset:18432
    ds_write_b32 v113, v105 offset:18448
    s_waitcnt lgkmcnt(0)
    s_barrier
    buffer_load_dwordx4 v[116:119], v108, s[20:23], s55 offen
    s_waitcnt vmcnt(9)
    v_perm_b32 v16, v20, v16, s84
    s_waitcnt vmcnt(7)
    v_perm_b32 v24, v28, v24, s84
    v_perm_b32 v18, v22, v18, s84
    v_perm_b32 v26, v30, v26, s84
    v_perm_b32 v17, v21, v17, s84
    v_perm_b32 v25, v29, v25, s84
    buffer_load_dwordx4 v[120:123], v109, s[20:23], s55 offen
    v_perm_b32 v19, v23, v19, s84
    v_perm_b32 v27, v31, v27, s84
    v_or_b32 v16, v114, v16
    v_or_b32 v24, v114, v24
    v_or_b32 v18, v114, v18
    v_or_b32 v26, v114, v26
    buffer_load_dwordx4 v[124:127], v110, s[20:23], s55 offen
    v_or_b32 v17, v114, v17
    v_or_b32 v25, v114, v25
    v_or_b32 v19, v114, v19
    v_or_b32 v27, v114, v27
    v_perm_b32 v88, v65, v64, v16
    v_perm_b32 v89, v65, v64, v24
    v_perm_b32 v90, v69, v68, v18
    buffer_load_dwordx4 v[128:131], v111, s[20:23], s55 offen
    v_perm_b32 v91, v69, v68, v26
    v_perm_b32 v92, v67, v66, v17
    v_perm_b32 v93, v67, v66, v25
    v_perm_b32 v94, v71, v70, v19
    v_perm_b32 v95, v71, v70, v27
    v_permlane16_swap_b32 v88, v90
    buffer_load_dwordx4 v[132:135], v108, s[20:23], s55 offen offset:256
    v_permlane16_swap_b32 v89, v91
    v_permlane16_swap_b32 v92, v94
    v_permlane16_swap_b32 v93, v95
    ds_write_b128 v112, v[88:91] offset:0
    ds_write_b128 v112, v[92:95] offset:1024
    s_waitcnt vmcnt(9)
    v_perm_b32 v32, v36, v32, s84
    s_waitcnt vmcnt(7)
    v_perm_b32 v40, v44, v40, s84
    buffer_load_dwordx4 v[136:139], v109, s[20:23], s55 offen offset:256
    v_perm_b32 v34, v38, v34, s84
    v_perm_b32 v42, v46, v42, s84
    v_perm_b32 v33, v37, v33, s84
    v_perm_b32 v41, v45, v41, s84
    v_perm_b32 v35, v39, v35, s84
    v_perm_b32 v43, v47, v43, s84
    buffer_load_dwordx4 v[140:143], v110, s[20:23], s55 offen offset:256
    v_or_b32 v32, v114, v32
    v_or_b32 v40, v114, v40
    v_or_b32 v34, v114, v34
    v_or_b32 v42, v114, v42
    v_or_b32 v33, v114, v33
    v_or_b32 v41, v114, v41
    buffer_load_dwordx4 v[144:147], v111, s[20:23], s55 offen offset:256
    v_or_b32 v35, v114, v35
    v_or_b32 v43, v114, v43
    v_perm_b32 v96, v73, v72, v32
    v_perm_b32 v97, v73, v72, v40
    v_perm_b32 v98, v77, v76, v34
    v_perm_b32 v99, v77, v76, v42
    v_perm_b32 v100, v75, v74, v33
    buffer_load_dwordx2 v[148:149], v84, s[20:23], s55 offen
    v_perm_b32 v101, v75, v74, v41
    v_perm_b32 v102, v79, v78, v35
    v_perm_b32 v103, v79, v78, v43
    v_permlane16_swap_b32 v96, v98
    v_permlane16_swap_b32 v97, v99
    v_permlane16_swap_b32 v100, v102
    buffer_load_dwordx2 v[150:151], v85, s[20:23], s55 offen
    v_permlane16_swap_b32 v101, v103
    ds_write_b128 v112, v[96:99] offset:8192
    ds_write_b128 v112, v[100:103] offset:9216
    s_waitcnt vmcnt(10)
    v_perm_b32 v48, v50, v48, s84
    v_perm_b32 v49, v51, v49, s84
    v_or_b32 v48, v114, v48
    v_or_b32 v49, v114, v49
    v_perm_b32 v104, v81, v80, v48
    v_perm_b32 v105, v83, v82, v49
    ds_write_b32 v113, v104 offset:0
    ds_write_b32 v113, v105 offset:16
    s_waitcnt lgkmcnt(0)
    s_barrier
    buffer_load_dwordx4 v[16:19], v108, s[20:23], s56 offen
    s_waitcnt vmcnt(9)
    v_perm_b32 v116, v120, v116, s84
    s_waitcnt vmcnt(7)
    v_perm_b32 v124, v128, v124, s84
    v_perm_b32 v118, v122, v118, s84
    v_perm_b32 v126, v130, v126, s84
    v_perm_b32 v117, v121, v117, s84
    v_perm_b32 v125, v129, v125, s84
    buffer_load_dwordx4 v[20:23], v109, s[20:23], s56 offen
    v_perm_b32 v119, v123, v119, s84
    v_perm_b32 v127, v131, v127, s84
    v_or_b32 v116, v114, v116
    v_or_b32 v124, v114, v124
    v_or_b32 v118, v114, v118
    v_or_b32 v126, v114, v126
    buffer_load_dwordx4 v[24:27], v110, s[20:23], s56 offen
    v_or_b32 v117, v114, v117
    v_or_b32 v125, v114, v125
    v_or_b32 v119, v114, v119
    v_or_b32 v127, v114, v127
    v_perm_b32 v88, v65, v64, v116
    v_perm_b32 v89, v65, v64, v124
    v_perm_b32 v90, v69, v68, v118
    buffer_load_dwordx4 v[28:31], v111, s[20:23], s56 offen
    v_perm_b32 v91, v69, v68, v126
    v_perm_b32 v92, v67, v66, v117
    v_perm_b32 v93, v67, v66, v125
    v_perm_b32 v94, v71, v70, v119
    v_perm_b32 v95, v71, v70, v127
    v_permlane16_swap_b32 v88, v90
    buffer_load_dwordx4 v[32:35], v108, s[20:23], s56 offen offset:256
    v_permlane16_swap_b32 v89, v91
    v_permlane16_swap_b32 v92, v94
    v_permlane16_swap_b32 v93, v95
    ds_write_b128 v112, v[88:91] offset:18432
    ds_write_b128 v112, v[92:95] offset:19456
    s_waitcnt vmcnt(9)
    v_perm_b32 v132, v136, v132, s84
    s_waitcnt vmcnt(7)
    v_perm_b32 v140, v144, v140, s84
    buffer_load_dwordx4 v[36:39], v109, s[20:23], s56 offen offset:256
    v_perm_b32 v134, v138, v134, s84
    v_perm_b32 v142, v146, v142, s84
    v_perm_b32 v133, v137, v133, s84
    v_perm_b32 v141, v145, v141, s84
    v_perm_b32 v135, v139, v135, s84
    v_perm_b32 v143, v147, v143, s84
    buffer_load_dwordx4 v[40:43], v110, s[20:23], s56 offen offset:256
    v_or_b32 v132, v114, v132
    v_or_b32 v140, v114, v140
    v_or_b32 v134, v114, v134
    v_or_b32 v142, v114, v142
    v_or_b32 v133, v114, v133
    v_or_b32 v141, v114, v141
    buffer_load_dwordx4 v[44:47], v111, s[20:23], s56 offen offset:256
    v_or_b32 v135, v114, v135
    v_or_b32 v143, v114, v143
    v_perm_b32 v96, v73, v72, v132
    v_perm_b32 v97, v73, v72, v140
    v_perm_b32 v98, v77, v76, v134
    v_perm_b32 v99, v77, v76, v142
    v_perm_b32 v100, v75, v74, v133
    buffer_load_dwordx2 v[48:49], v84, s[20:23], s56 offen
    v_perm_b32 v101, v75, v74, v141
    v_perm_b32 v102, v79, v78, v135
    v_perm_b32 v103, v79, v78, v143
    v_permlane16_swap_b32 v96, v98
    v_permlane16_swap_b32 v97, v99
    v_permlane16_swap_b32 v100, v102
    buffer_load_dwordx2 v[50:51], v85, s[20:23], s56 offen
    v_permlane16_swap_b32 v101, v103
    ds_write_b128 v112, v[96:99] offset:26624
    ds_write_b128 v112, v[100:103] offset:27648
    s_waitcnt vmcnt(10)
    v_perm_b32 v148, v150, v148, s84
    v_perm_b32 v149, v151, v149, s84
    v_or_b32 v148, v114, v148
    v_or_b32 v149, v114, v149
    v_perm_b32 v104, v81, v80, v148
    v_perm_b32 v105, v83, v82, v149
    ds_write_b32 v113, v104 offset:18432
    ds_write_b32 v113, v105 offset:18448
    s_waitcnt lgkmcnt(0)
    s_barrier
    s_waitcnt vmcnt(8)
    v_perm_b32 v16, v20, v16, s84
    s_waitcnt vmcnt(6)
    v_perm_b32 v24, v28, v24, s84
    v_perm_b32 v18, v22, v18, s84
    v_perm_b32 v26, v30, v26, s84
    v_perm_b32 v17, v21, v17, s84
    v_perm_b32 v25, v29, v25, s84
    v_perm_b32 v19, v23, v19, s84
    v_perm_b32 v27, v31, v27, s84
    v_or_b32 v16, v114, v16
    v_or_b32 v24, v114, v24
    v_or_b32 v18, v114, v18
    v_or_b32 v26, v114, v26
    v_or_b32 v17, v114, v17
    v_or_b32 v25, v114, v25
    v_or_b32 v19, v114, v19
    v_or_b32 v27, v114, v27
    v_perm_b32 v88, v65, v64, v16
    v_perm_b32 v89, v65, v64, v24
    v_perm_b32 v90, v69, v68, v18
    v_perm_b32 v91, v69, v68, v26
    v_perm_b32 v92, v67, v66, v17
    v_perm_b32 v93, v67, v66, v25
    v_perm_b32 v94, v71, v70, v19
    v_perm_b32 v95, v71, v70, v27
    v_permlane16_swap_b32 v88, v90
    v_permlane16_swap_b32 v89, v91
    v_permlane16_swap_b32 v92, v94
    v_permlane16_swap_b32 v93, v95
    ds_write_b128 v112, v[88:91] offset:0
    ds_write_b128 v112, v[92:95] offset:1024
    s_waitcnt vmcnt(4)
    v_perm_b32 v32, v36, v32, s84
    s_waitcnt vmcnt(2)
    v_perm_b32 v40, v44, v40, s84
    v_perm_b32 v34, v38, v34, s84
    v_perm_b32 v42, v46, v42, s84
    v_perm_b32 v33, v37, v33, s84
    v_perm_b32 v41, v45, v41, s84
    v_perm_b32 v35, v39, v35, s84
    v_perm_b32 v43, v47, v43, s84
    v_or_b32 v32, v114, v32
    v_or_b32 v40, v114, v40
    v_or_b32 v34, v114, v34
    v_or_b32 v42, v114, v42
    v_or_b32 v33, v114, v33
    v_or_b32 v41, v114, v41
    v_or_b32 v35, v114, v35
    v_or_b32 v43, v114, v43
    v_perm_b32 v96, v73, v72, v32
    v_perm_b32 v97, v73, v72, v40
    v_perm_b32 v98, v77, v76, v34
    v_perm_b32 v99, v77, v76, v42
    v_perm_b32 v100, v75, v74, v33
    v_perm_b32 v101, v75, v74, v41
    v_perm_b32 v102, v79, v78, v35
    v_perm_b32 v103, v79, v78, v43
    v_permlane16_swap_b32 v96, v98
    v_permlane16_swap_b32 v97, v99
    v_permlane16_swap_b32 v100, v102
    v_permlane16_swap_b32 v101, v103
    ds_write_b128 v112, v[96:99] offset:8192
    ds_write_b128 v112, v[100:103] offset:9216
    s_waitcnt vmcnt(0)
    v_perm_b32 v48, v50, v48, s84
    v_perm_b32 v49, v51, v49, s84
    v_or_b32 v48, v114, v48
    v_or_b32 v49, v114, v49
    v_perm_b32 v104, v81, v80, v48
    v_perm_b32 v105, v83, v82, v49
    ds_write_b32 v113, v104 offset:0
    ds_write_b32 v113, v105 offset:16
    s_waitcnt lgkmcnt(0)
    s_barrier
    s_endpgm
L_consumer2:
    s_barrier
    s_waitcnt vmcnt(8)
    ds_read_b128 v[160:163], v228 offset:0
    ds_read_b128 v[192:195], v232 offset:0
    ds_read_b128 v[164:167], v228 offset:2048
    ds_read_b128 v[168:171], v228 offset:4096
    ds_read_b128 v[172:175], v228 offset:6144
    ds_read_b128 v[196:199], v232 offset:1024
    ds_read_b128 v[200:203], v232 offset:2048
    s_waitcnt lgkmcnt(5)
    v_mfma_f32_16x16x32_bf16 v[16:19], v[160:163], v[192:195], 0
    s_add_u32 m0, s98, 65536
    s_nop 0
    buffer_load_dwordx4 v245, s[16:19], s64 offen lds
    s_waitcnt lgkmcnt(4)
    v_mfma_f32_16x16x32_bf16 v[20:23], v[164:167], v[192:195], 0
    s_waitcnt lgkmcnt(3)
    v_mfma_f32_16x16x32_bf16 v[24:27], v[168:171], v[192:195], 0
    s_waitcnt lgkmcnt(2)
    v_mfma_f32_16x16x32_bf16 v[28:31], v[172:175], v[192:195], 0
    ds_read_b128 v[204:207], v232 offset:3072
    s_waitcnt lgkmcnt(2)
    v_mfma_f32_16x16x32_bf16 v[32:35], v[160:163], v[196:199], 0
    v_mfma_f32_16x16x32_bf16 v[36:39], v[164:167], v[196:199], 0
    v_mfma_f32_16x16x32_bf16 v[40:43], v[168:171], v[196:199], 0
    v_mfma_f32_16x16x32_bf16 v[44:47], v[172:175], v[196:199], 0
    ds_read_b128 v[208:211], v232 offset:8192
    s_waitcnt lgkmcnt(2)
    v_mfma_f32_16x16x32_bf16 v[48:51], v[160:163], v[200:203], 0
    v_mfma_f32_16x16x32_bf16 v[52:55], v[164:167], v[200:203], 0
    buffer_load_dwordx4 v246, s[16:19], s64 offen offset:1024 lds
    v_mfma_f32_16x16x32_bf16 v[56:59], v[168:171], v[200:203], 0
    v_mfma_f32_16x16x32_bf16 v[60:63], v[172:175], v[200:203], 0
    ds_read_b128 v[212:215], v232 offset:9216
    s_waitcnt lgkmcnt(2)
    v_mfma_f32_16x16x32_bf16 v[64:67], v[160:163], v[204:207], 0
    v_mfma_f32_16x16x32_bf16 v[68:71], v[164:167], v[204:207], 0
    v_mfma_f32_16x16x32_bf16 v[72:75], v[168:171], v[204:207], 0
    v_mfma_f32_16x16x32_bf16 v[76:79], v[172:175], v[204:207], 0
    ds_read_b128 v[192:195], v232 offset:10240
    ds_read_b128 v[176:179], v229 offset:0
    s_waitcnt lgkmcnt(3)
    v_mfma_f32_16x16x32_bf16 v[80:83], v[160:163], v[208:211], 0
    ds_read_b128 v[180:183], v229 offset:2048
    v_mfma_f32_16x16x32_bf16 v[84:87], v[164:167], v[208:211], 0
    ds_read_b128 v[184:187], v229 offset:4096
    v_mfma_f32_16x16x32_bf16 v[88:91], v[168:171], v[208:211], 0
    buffer_load_dwordx4 v247, s[16:19], s64 offen offset:2048 lds
    ds_read_b128 v[188:191], v229 offset:6144
    v_mfma_f32_16x16x32_bf16 v[92:95], v[172:175], v[208:211], 0
    ds_read_b128 v[196:199], v232 offset:11264
    s_waitcnt lgkmcnt(6)
    v_mfma_f32_16x16x32_bf16 v[96:99], v[160:163], v[212:215], 0
    v_mfma_f32_16x16x32_bf16 v[100:103], v[164:167], v[212:215], 0
    v_mfma_f32_16x16x32_bf16 v[104:107], v[168:171], v[212:215], 0
    v_mfma_f32_16x16x32_bf16 v[108:111], v[172:175], v[212:215], 0
    ds_read_b128 v[216:219], v232 offset:16384
    s_waitcnt lgkmcnt(6)
    v_mfma_f32_16x16x32_bf16 v[112:115], v[160:163], v[192:195], 0
    v_mfma_f32_16x16x32_bf16 v[116:119], v[164:167], v[192:195], 0
    v_mfma_f32_16x16x32_bf16 v[120:123], v[168:171], v[192:195], 0
    v_mfma_f32_16x16x32_bf16 v[124:127], v[172:175], v[192:195], 0
    buffer_load_dwordx4 v248, s[16:19], s64 offen offset:3072 lds
    ds_read_b128 v[200:203], v232 offset:4096
    s_waitcnt lgkmcnt(2)
    v_mfma_f32_16x16x32_bf16 v[128:131], v[160:163], v[196:199], 0
    v_mfma_f32_16x16x32_bf16 v[132:135], v[164:167], v[196:199], 0
    v_mfma_f32_16x16x32_bf16 v[136:139], v[168:171], v[196:199], 0
    v_mfma_f32_16x16x32_bf16 v[140:143], v[172:175], v[196:199], 0
    ds_read_b128 v[204:207], v232 offset:5120
    s_waitcnt lgkmcnt(2)
    v_mfma_f32_16x16x32_bf16 v[144:147], v[216:219], v[160:163], 0
    v_mfma_f32_16x16x32_bf16 v[148:151], v[216:219], v[164:167], 0
    v_mfma_f32_16x16x32_bf16 v[152:155], v[216:219], v[168:171], 0
    v_mfma_f32_16x16x32_bf16 v[156:159], v[216:219], v[172:175], 0
    s_add_u32 m0, s98, 69632
    ds_read_b128 v[208:211], v232 offset:6144
    s_waitcnt lgkmcnt(2)
    v_mfma_f32_16x16x32_bf16 v[16:19], v[176:179], v[200:203], v[16:19]
    buffer_load_dwordx4 v245, s[16:19], s65 offen lds
    v_mfma_f32_16x16x32_bf16 v[20:23], v[180:183], v[200:203], v[20:23]
    v_mfma_f32_16x16x32_bf16 v[24:27], v[184:187], v[200:203], v[24:27]
    v_mfma_f32_16x16x32_bf16 v[28:31], v[188:191], v[200:203], v[28:31]
    ds_read_b128 v[212:215], v232 offset:7168
    s_waitcnt lgkmcnt(2)
    v_mfma_f32_16x16x32_bf16 v[32:35], v[176:179], v[204:207], v[32:35]
    v_mfma_f32_16x16x32_bf16 v[36:39], v[180:183], v[204:207], v[36:39]
    v_mfma_f32_16x16x32_bf16 v[40:43], v[184:187], v[204:207], v[40:43]
    v_mfma_f32_16x16x32_bf16 v[44:47], v[188:191], v[204:207], v[44:47]
    ds_read_b128 v[192:195], v232 offset:12288
    s_waitcnt lgkmcnt(2)
    v_mfma_f32_16x16x32_bf16 v[48:51], v[176:179], v[208:211], v[48:51]
    v_mfma_f32_16x16x32_bf16 v[52:55], v[180:183], v[208:211], v[52:55]
    buffer_load_dwordx4 v246, s[16:19], s65 offen offset:1024 lds
    v_mfma_f32_16x16x32_bf16 v[56:59], v[184:187], v[208:211], v[56:59]
    v_mfma_f32_16x16x32_bf16 v[60:63], v[188:191], v[208:211], v[60:63]
    ds_read_b128 v[196:199], v232 offset:13312
    s_waitcnt lgkmcnt(2)
    v_mfma_f32_16x16x32_bf16 v[64:67], v[176:179], v[212:215], v[64:67]
    v_mfma_f32_16x16x32_bf16 v[68:71], v[180:183], v[212:215], v[68:71]
    v_mfma_f32_16x16x32_bf16 v[72:75], v[184:187], v[212:215], v[72:75]
    v_mfma_f32_16x16x32_bf16 v[76:79], v[188:191], v[212:215], v[76:79]
    ds_read_b128 v[200:203], v232 offset:14336
    s_waitcnt lgkmcnt(2)
    v_mfma_f32_16x16x32_bf16 v[80:83], v[176:179], v[192:195], v[80:83]
    v_mfma_f32_16x16x32_bf16 v[84:87], v[180:183], v[192:195], v[84:87]
    v_mfma_f32_16x16x32_bf16 v[88:91], v[184:187], v[192:195], v[88:91]
    buffer_load_dwordx4 v247, s[16:19], s65 offen offset:2048 lds
    v_mfma_f32_16x16x32_bf16 v[92:95], v[188:191], v[192:195], v[92:95]
    ds_read_b128 v[204:207], v232 offset:15360
    s_waitcnt lgkmcnt(2)
    v_mfma_f32_16x16x32_bf16 v[96:99], v[176:179], v[196:199], v[96:99]
    v_mfma_f32_16x16x32_bf16 v[100:103], v[180:183], v[196:199], v[100:103]
    v_mfma_f32_16x16x32_bf16 v[104:107], v[184:187], v[196:199], v[104:107]
    v_mfma_f32_16x16x32_bf16 v[108:111], v[188:191], v[196:199], v[108:111]
    ds_read_b128 v[220:223], v232 offset:17408
    s_waitcnt lgkmcnt(2)
    v_mfma_f32_16x16x32_bf16 v[112:115], v[176:179], v[200:203], v[112:115]
    v_mfma_f32_16x16x32_bf16 v[116:119], v[180:183], v[200:203], v[116:119]
    v_mfma_f32_16x16x32_bf16 v[120:123], v[184:187], v[200:203], v[120:123]
    v_mfma_f32_16x16x32_bf16 v[124:127], v[188:191], v[200:203], v[124:127]
    buffer_load_dwordx4 v248, s[16:19], s65 offen offset:3072 lds
    s_waitcnt lgkmcnt(1)
    v_mfma_f32_16x16x32_bf16 v[128:131], v[176:179], v[204:207], v[128:131]
    v_mfma_f32_16x16x32_bf16 v[132:135], v[180:183], v[204:207], v[132:135]
    v_mfma_f32_16x16x32_bf16 v[136:139], v[184:187], v[204:207], v[136:139]
    v_mfma_f32_16x16x32_bf16 v[140:143], v[188:191], v[204:207], v[140:143]
    s_waitcnt lgkmcnt(0)
    v_mfma_f32_16x16x32_bf16 v[144:147], v[220:223], v[176:179], v[144:147]
    v_mfma_f32_16x16x32_bf16 v[148:151], v[220:223], v[180:183], v[148:151]
    v_mfma_f32_16x16x32_bf16 v[152:155], v[220:223], v[184:187], v[152:155]
    v_mfma_f32_16x16x32_bf16 v[156:159], v[220:223], v[188:191], v[156:159]
    s_barrier
    s_waitcnt vmcnt(8)
    ds_read_b128 v[160:163], v228 offset:32768
    ds_read_b128 v[208:211], v232 offset:18432
    ds_read_b128 v[164:167], v228 offset:34816
    ds_read_b128 v[168:171], v228 offset:36864
    ds_read_b128 v[172:175], v228 offset:38912
    ds_read_b128 v[212:215], v232 offset:19456
    ds_read_b128 v[192:195], v232 offset:20480
    s_waitcnt lgkmcnt(5)
    v_mfma_f32_16x16x32_bf16 v[16:19], v[160:163], v[208:211], v[16:19]
    s_add_u32 m0, s98, 0
    s_nop 0
    buffer_load_dwordx4 v245, s[16:19], s66 offen lds
    s_waitcnt lgkmcnt(4)
    v_mfma_f32_16x16x32_bf16 v[20:23], v[164:167], v[208:211], v[20:23]
    s_waitcnt lgkmcnt(3)
    v_mfma_f32_16x16x32_bf16 v[24:27], v[168:171], v[208:211], v[24:27]
    s_waitcnt lgkmcnt(2)
    v_mfma_f32_16x16x32_bf16 v[28:31], v[172:175], v[208:211], v[28:31]
    ds_read_b128 v[196:199], v232 offset:21504
    s_waitcnt lgkmcnt(2)
    v_mfma_f32_16x16x32_bf16 v[32:35], v[160:163], v[212:215], v[32:35]
    v_mfma_f32_16x16x32_bf16 v[36:39], v[164:167], v[212:215], v[36:39]
    v_mfma_f32_16x16x32_bf16 v[40:43], v[168:171], v[212:215], v[40:43]
    v_mfma_f32_16x16x32_bf16 v[44:47], v[172:175], v[212:215], v[44:47]
    ds_read_b128 v[200:203], v232 offset:26624
    s_waitcnt lgkmcnt(2)
    v_mfma_f32_16x16x32_bf16 v[48:51], v[160:163], v[192:195], v[48:51]
    v_mfma_f32_16x16x32_bf16 v[52:55], v[164:167], v[192:195], v[52:55]
    buffer_load_dwordx4 v246, s[16:19], s66 offen offset:1024 lds
    v_mfma_f32_16x16x32_bf16 v[56:59], v[168:171], v[192:195], v[56:59]
    v_mfma_f32_16x16x32_bf16 v[60:63], v[172:175], v[192:195], v[60:63]
    ds_read_b128 v[204:207], v232 offset:27648
    s_waitcnt lgkmcnt(2)
    v_mfma_f32_16x16x32_bf16 v[64:67], v[160:163], v[196:199], v[64:67]
    v_mfma_f32_16x16x32_bf16 v[68:71], v[164:167], v[196:199], v[68:71]
    v_mfma_f32_16x16x32_bf16 v[72:75], v[168:171], v[196:199], v[72:75]
    v_mfma_f32_16x16x32_bf16 v[76:79], v[172:175], v[196:199], v[76:79]
    ds_read_b128 v[208:211], v232 offset:28672
    ds_read_b128 v[176:179], v229 offset:32768
    s_waitcnt lgkmcnt(3)
    v_mfma_f32_16x16x32_bf16 v[80:83], v[160:163], v[200:203], v[80:83]
    ds_read_b128 v[180:183], v229 offset:34816
    v_mfma_f32_16x16x32_bf16 v[84:87], v[164:167], v[200:203], v[84:87]
    ds_read_b128 v[184:187], v229 offset:36864
    v_mfma_f32_16x16x32_bf16 v[88:91], v[168:171], v[200:203], v[88:91]
    buffer_load_dwordx4 v247, s[16:19], s66 offen offset:2048 lds
    ds_read_b128 v[188:191], v229 offset:38912
    v_mfma_f32_16x16x32_bf16 v[92:95], v[172:175], v[200:203], v[92:95]
    ds_read_b128 v[212:215], v232 offset:29696
    s_waitcnt lgkmcnt(6)
    v_mfma_f32_16x16x32_bf16 v[96:99], v[160:163], v[204:207], v[96:99]
    v_mfma_f32_16x16x32_bf16 v[100:103], v[164:167], v[204:207], v[100:103]
    v_mfma_f32_16x16x32_bf16 v[104:107], v[168:171], v[204:207], v[104:107]
    v_mfma_f32_16x16x32_bf16 v[108:111], v[172:175], v[204:207], v[108:111]
    ds_read_b128 v[216:219], v232 offset:34816
    s_waitcnt lgkmcnt(6)
    v_mfma_f32_16x16x32_bf16 v[112:115], v[160:163], v[208:211], v[112:115]
    v_mfma_f32_16x16x32_bf16 v[116:119], v[164:167], v[208:211], v[116:119]
    v_mfma_f32_16x16x32_bf16 v[120:123], v[168:171], v[208:211], v[120:123]
    v_mfma_f32_16x16x32_bf16 v[124:127], v[172:175], v[208:211], v[124:127]
    buffer_load_dwordx4 v248, s[16:19], s66 offen offset:3072 lds
    ds_read_b128 v[192:195], v232 offset:22528
    s_waitcnt lgkmcnt(2)
    v_mfma_f32_16x16x32_bf16 v[128:131], v[160:163], v[212:215], v[128:131]
    v_mfma_f32_16x16x32_bf16 v[132:135], v[164:167], v[212:215], v[132:135]
    v_mfma_f32_16x16x32_bf16 v[136:139], v[168:171], v[212:215], v[136:139]
    v_mfma_f32_16x16x32_bf16 v[140:143], v[172:175], v[212:215], v[140:143]
    ds_read_b128 v[196:199], v232 offset:23552
    s_waitcnt lgkmcnt(2)
    v_mfma_f32_16x16x32_bf16 v[144:147], v[216:219], v[160:163], v[144:147]
    v_mfma_f32_16x16x32_bf16 v[148:151], v[216:219], v[164:167], v[148:151]
    v_mfma_f32_16x16x32_bf16 v[152:155], v[216:219], v[168:171], v[152:155]
    v_mfma_f32_16x16x32_bf16 v[156:159], v[216:219], v[172:175], v[156:159]
    s_add_u32 m0, s98, 4096
    ds_read_b128 v[200:203], v232 offset:24576
    s_waitcnt lgkmcnt(2)
    v_mfma_f32_16x16x32_bf16 v[16:19], v[176:179], v[192:195], v[16:19]
    buffer_load_dwordx4 v245, s[16:19], s67 offen lds
    v_mfma_f32_16x16x32_bf16 v[20:23], v[180:183], v[192:195], v[20:23]
    v_mfma_f32_16x16x32_bf16 v[24:27], v[184:187], v[192:195], v[24:27]
    v_mfma_f32_16x16x32_bf16 v[28:31], v[188:191], v[192:195], v[28:31]
    ds_read_b128 v[204:207], v232 offset:25600
    s_waitcnt lgkmcnt(2)
    v_mfma_f32_16x16x32_bf16 v[32:35], v[176:179], v[196:199], v[32:35]
    v_mfma_f32_16x16x32_bf16 v[36:39], v[180:183], v[196:199], v[36:39]
    v_mfma_f32_16x16x32_bf16 v[40:43], v[184:187], v[196:199], v[40:43]
    v_mfma_f32_16x16x32_bf16 v[44:47], v[188:191], v[196:199], v[44:47]
    ds_read_b128 v[208:211], v232 offset:30720
    s_waitcnt lgkmcnt(2)
    v_mfma_f32_16x16x32_bf16 v[48:51], v[176:179], v[200:203], v[48:51]
    v_mfma_f32_16x16x32_bf16 v[52:55], v[180:183], v[200:203], v[52:55]
    buffer_load_dwordx4 v246, s[16:19], s67 offen offset:1024 lds
    v_mfma_f32_16x16x32_bf16 v[56:59], v[184:187], v[200:203], v[56:59]
    v_mfma_f32_16x16x32_bf16 v[60:63], v[188:191], v[200:203], v[60:63]
    ds_read_b128 v[212:215], v232 offset:31744
    s_waitcnt lgkmcnt(2)
    v_mfma_f32_16x16x32_bf16 v[64:67], v[176:179], v[204:207], v[64:67]
    v_mfma_f32_16x16x32_bf16 v[68:71], v[180:183], v[204:207], v[68:71]
    v_mfma_f32_16x16x32_bf16 v[72:75], v[184:187], v[204:207], v[72:75]
    v_mfma_f32_16x16x32_bf16 v[76:79], v[188:191], v[204:207], v[76:79]
    ds_read_b128 v[192:195], v232 offset:32768
    s_waitcnt lgkmcnt(2)
    v_mfma_f32_16x16x32_bf16 v[80:83], v[176:179], v[208:211], v[80:83]
    v_mfma_f32_16x16x32_bf16 v[84:87], v[180:183], v[208:211], v[84:87]
    v_mfma_f32_16x16x32_bf16 v[88:91], v[184:187], v[208:211], v[88:91]
    buffer_load_dwordx4 v247, s[16:19], s67 offen offset:2048 lds
    v_mfma_f32_16x16x32_bf16 v[92:95], v[188:191], v[208:211], v[92:95]
    ds_read_b128 v[196:199], v232 offset:33792
    s_waitcnt lgkmcnt(2)
    v_mfma_f32_16x16x32_bf16 v[96:99], v[176:179], v[212:215], v[96:99]
    v_mfma_f32_16x16x32_bf16 v[100:103], v[180:183], v[212:215], v[100:103]
    v_mfma_f32_16x16x32_bf16 v[104:107], v[184:187], v[212:215], v[104:107]
    v_mfma_f32_16x16x32_bf16 v[108:111], v[188:191], v[212:215], v[108:111]
    ds_read_b128 v[220:223], v232 offset:35840
    s_waitcnt lgkmcnt(2)
    v_mfma_f32_16x16x32_bf16 v[112:115], v[176:179], v[192:195], v[112:115]
    v_mfma_f32_16x16x32_bf16 v[116:119], v[180:183], v[192:195], v[116:119]
    v_mfma_f32_16x16x32_bf16 v[120:123], v[184:187], v[192:195], v[120:123]
    v_mfma_f32_16x16x32_bf16 v[124:127], v[188:191], v[192:195], v[124:127]
    buffer_load_dwordx4 v248, s[16:19], s67 offen offset:3072 lds
    s_waitcnt lgkmcnt(1)
    v_mfma_f32_16x16x32_bf16 v[128:131], v[176:179], v[196:199], v[128:131]
    v_mfma_f32_16x16x32_bf16 v[132:135], v[180:183], v[196:199], v[132:135]
    v_mfma_f32_16x16x32_bf16 v[136:139], v[184:187], v[196:199], v[136:139]
    v_mfma_f32_16x16x32_bf16 v[140:143], v[188:191], v[196:199], v[140:143]
    s_waitcnt lgkmcnt(0)
    v_mfma_f32_16x16x32_bf16 v[144:147], v[220:223], v[176:179], v[144:147]
    v_mfma_f32_16x16x32_bf16 v[148:151], v[220:223], v[180:183], v[148:151]
    v_mfma_f32_16x16x32_bf16 v[152:155], v[220:223], v[184:187], v[152:155]
    v_mfma_f32_16x16x32_bf16 v[156:159], v[220:223], v[188:191], v[156:159]
    s_barrier
    s_waitcnt vmcnt(8)
    ds_read_b128 v[160:163], v230 offset:0
    ds_read_b128 v[200:203], v232 offset:0
    ds_read_b128 v[164:167], v230 offset:2048
    ds_read_b128 v[168:171], v230 offset:4096
    ds_read_b128 v[172:175], v230 offset:6144
    ds_read_b128 v[204:207], v232 offset:1024
    ds_read_b128 v[208:211], v232 offset:2048
    s_waitcnt lgkmcnt(5)
    v_mfma_f32_16x16x32_bf16 v[16:19], v[160:163], v[200:203], v[16:19]
    s_add_u32 m0, s98, 32768
    s_nop 0
    buffer_load_dwordx4 v245, s[16:19], s68 offen lds
    s_waitcnt lgkmcnt(4)
    v_mfma_f32_16x16x32_bf16 v[20:23], v[164:167], v[200:203], v[20:23]
    s_waitcnt lgkmcnt(3)
    v_mfma_f32_16x16x32_bf16 v[24:27], v[168:171], v[200:203], v[24:27]
    s_waitcnt lgkmcnt(2)
    v_mfma_f32_16x16x32_bf16 v[28:31], v[172:175], v[200:203], v[28:31]
    ds_read_b128 v[212:215], v232 offset:3072
    s_waitcnt lgkmcnt(2)
    v_mfma_f32_16x16x32_bf16 v[32:35], v[160:163], v[204:207], v[32:35]
    v_mfma_f32_16x16x32_bf16 v[36:39], v[164:167], v[204:207], v[36:39]
    v_mfma_f32_16x16x32_bf16 v[40:43], v[168:171], v[204:207], v[40:43]
    v_mfma_f32_16x16x32_bf16 v[44:47], v[172:175], v[204:207], v[44:47]
    ds_read_b128 v[192:195], v232 offset:8192
    s_waitcnt lgkmcnt(2)
    v_mfma_f32_16x16x32_bf16 v[48:51], v[160:163], v[208:211], v[48:51]
    v_mfma_f32_16x16x32_bf16 v[52:55], v[164:167], v[208:211], v[52:55]
    buffer_load_dwordx4 v246, s[16:19], s68 offen offset:1024 lds
    v_mfma_f32_16x16x32_bf16 v[56:59], v[168:171], v[208:211], v[56:59]
    v_mfma_f32_16x16x32_bf16 v[60:63], v[172:175], v[208:211], v[60:63]
    ds_read_b128 v[196:199], v232 offset:9216
    s_waitcnt lgkmcnt(2)
    v_mfma_f32_16x16x32_bf16 v[64:67], v[160:163], v[212:215], v[64:67]
    v_mfma_f32_16x16x32_bf16 v[68:71], v[164:167], v[212:215], v[68:71]
    v_mfma_f32_16x16x32_bf16 v[72:75], v[168:171], v[212:215], v[72:75]
    v_mfma_f32_16x16x32_bf16 v[76:79], v[172:175], v[212:215], v[76:79]
    ds_read_b128 v[200:203], v232 offset:10240
    ds_read_b128 v[176:179], v231 offset:0
    s_waitcnt lgkmcnt(3)
    v_mfma_f32_16x16x32_bf16 v[80:83], v[160:163], v[192:195], v[80:83]
    ds_read_b128 v[180:183], v231 offset:2048
    v_mfma_f32_16x16x32_bf16 v[84:87], v[164:167], v[192:195], v[84:87]
    ds_read_b128 v[184:187], v231 offset:4096
    v_mfma_f32_16x16x32_bf16 v[88:91], v[168:171], v[192:195], v[88:91]
    buffer_load_dwordx4 v247, s[16:19], s68 offen offset:2048 lds
    ds_read_b128 v[188:191], v231 offset:6144
    v_mfma_f32_16x16x32_bf16 v[92:95], v[172:175], v[192:195], v[92:95]
    ds_read_b128 v[204:207], v232 offset:11264
    s_waitcnt lgkmcnt(6)
    v_mfma_f32_16x16x32_bf16 v[96:99], v[160:163], v[196:199], v[96:99]
    v_mfma_f32_16x16x32_bf16 v[100:103], v[164:167], v[196:199], v[100:103]
    v_mfma_f32_16x16x32_bf16 v[104:107], v[168:171], v[196:199], v[104:107]
    v_mfma_f32_16x16x32_bf16 v[108:111], v[172:175], v[196:199], v[108:111]
    ds_read_b128 v[216:219], v232 offset:16384
    s_waitcnt lgkmcnt(6)
    v_mfma_f32_16x16x32_bf16 v[112:115], v[160:163], v[200:203], v[112:115]
    v_mfma_f32_16x16x32_bf16 v[116:119], v[164:167], v[200:203], v[116:119]
    v_mfma_f32_16x16x32_bf16 v[120:123], v[168:171], v[200:203], v[120:123]
    v_mfma_f32_16x16x32_bf16 v[124:127], v[172:175], v[200:203], v[124:127]
    buffer_load_dwordx4 v248, s[16:19], s68 offen offset:3072 lds
    ds_read_b128 v[208:211], v232 offset:4096
    s_waitcnt lgkmcnt(2)
    v_mfma_f32_16x16x32_bf16 v[128:131], v[160:163], v[204:207], v[128:131]
    v_mfma_f32_16x16x32_bf16 v[132:135], v[164:167], v[204:207], v[132:135]
    v_mfma_f32_16x16x32_bf16 v[136:139], v[168:171], v[204:207], v[136:139]
    v_mfma_f32_16x16x32_bf16 v[140:143], v[172:175], v[204:207], v[140:143]
    ds_read_b128 v[212:215], v232 offset:5120
    s_waitcnt lgkmcnt(2)
    v_mfma_f32_16x16x32_bf16 v[144:147], v[216:219], v[160:163], v[144:147]
    v_mfma_f32_16x16x32_bf16 v[148:151], v[216:219], v[164:167], v[148:151]
    v_mfma_f32_16x16x32_bf16 v[152:155], v[216:219], v[168:171], v[152:155]
    v_mfma_f32_16x16x32_bf16 v[156:159], v[216:219], v[172:175], v[156:159]
    s_add_u32 m0, s98, 36864
    ds_read_b128 v[192:195], v232 offset:6144
    s_waitcnt lgkmcnt(2)
    v_mfma_f32_16x16x32_bf16 v[16:19], v[176:179], v[208:211], v[16:19]
    buffer_load_dwordx4 v245, s[16:19], s69 offen lds
    v_mfma_f32_16x16x32_bf16 v[20:23], v[180:183], v[208:211], v[20:23]
    v_mfma_f32_16x16x32_bf16 v[24:27], v[184:187], v[208:211], v[24:27]
    v_mfma_f32_16x16x32_bf16 v[28:31], v[188:191], v[208:211], v[28:31]
    ds_read_b128 v[196:199], v232 offset:7168
    s_waitcnt lgkmcnt(2)
    v_mfma_f32_16x16x32_bf16 v[32:35], v[176:179], v[212:215], v[32:35]
    v_mfma_f32_16x16x32_bf16 v[36:39], v[180:183], v[212:215], v[36:39]
    v_mfma_f32_16x16x32_bf16 v[40:43], v[184:187], v[212:215], v[40:43]
    v_mfma_f32_16x16x32_bf16 v[44:47], v[188:191], v[212:215], v[44:47]
    ds_read_b128 v[200:203], v232 offset:12288
    s_waitcnt lgkmcnt(2)
    v_mfma_f32_16x16x32_bf16 v[48:51], v[176:179], v[192:195], v[48:51]
    v_mfma_f32_16x16x32_bf16 v[52:55], v[180:183], v[192:195], v[52:55]
    buffer_load_dwordx4 v246, s[16:19], s69 offen offset:1024 lds
    v_mfma_f32_16x16x32_bf16 v[56:59], v[184:187], v[192:195], v[56:59]
    v_mfma_f32_16x16x32_bf16 v[60:63], v[188:191], v[192:195], v[60:63]
    ds_read_b128 v[204:207], v232 offset:13312
    s_waitcnt lgkmcnt(2)
    v_mfma_f32_16x16x32_bf16 v[64:67], v[176:179], v[196:199], v[64:67]
    v_mfma_f32_16x16x32_bf16 v[68:71], v[180:183], v[196:199], v[68:71]
    v_mfma_f32_16x16x32_bf16 v[72:75], v[184:187], v[196:199], v[72:75]
    v_mfma_f32_16x16x32_bf16 v[76:79], v[188:191], v[196:199], v[76:79]
    ds_read_b128 v[208:211], v232 offset:14336
    s_waitcnt lgkmcnt(2)
    v_mfma_f32_16x16x32_bf16 v[80:83], v[176:179], v[200:203], v[80:83]
    v_mfma_f32_16x16x32_bf16 v[84:87], v[180:183], v[200:203], v[84:87]
    v_mfma_f32_16x16x32_bf16 v[88:91], v[184:187], v[200:203], v[88:91]
    buffer_load_dwordx4 v247, s[16:19], s69 offen offset:2048 lds
    v_mfma_f32_16x16x32_bf16 v[92:95], v[188:191], v[200:203], v[92:95]
    ds_read_b128 v[212:215], v232 offset:15360
    s_waitcnt lgkmcnt(2)
    v_mfma_f32_16x16x32_bf16 v[96:99], v[176:179], v[204:207], v[96:99]
    v_mfma_f32_16x16x32_bf16 v[100:103], v[180:183], v[204:207], v[100:103]
    v_mfma_f32_16x16x32_bf16 v[104:107], v[184:187], v[204:207], v[104:107]
    v_mfma_f32_16x16x32_bf16 v[108:111], v[188:191], v[204:207], v[108:111]
    ds_read_b128 v[220:223], v232 offset:17408
    s_waitcnt lgkmcnt(2)
    v_mfma_f32_16x16x32_bf16 v[112:115], v[176:179], v[208:211], v[112:115]
    v_mfma_f32_16x16x32_bf16 v[116:119], v[180:183], v[208:211], v[116:119]
    v_mfma_f32_16x16x32_bf16 v[120:123], v[184:187], v[208:211], v[120:123]
    v_mfma_f32_16x16x32_bf16 v[124:127], v[188:191], v[208:211], v[124:127]
    buffer_load_dwordx4 v248, s[16:19], s69 offen offset:3072 lds
    s_waitcnt lgkmcnt(1)
    v_mfma_f32_16x16x32_bf16 v[128:131], v[176:179], v[212:215], v[128:131]
    v_mfma_f32_16x16x32_bf16 v[132:135], v[180:183], v[212:215], v[132:135]
    v_mfma_f32_16x16x32_bf16 v[136:139], v[184:187], v[212:215], v[136:139]
    v_mfma_f32_16x16x32_bf16 v[140:143], v[188:191], v[212:215], v[140:143]
    s_waitcnt lgkmcnt(0)
    v_mfma_f32_16x16x32_bf16 v[144:147], v[220:223], v[176:179], v[144:147]
    v_mfma_f32_16x16x32_bf16 v[148:151], v[220:223], v[180:183], v[148:151]
    v_mfma_f32_16x16x32_bf16 v[152:155], v[220:223], v[184:187], v[152:155]
    v_mfma_f32_16x16x32_bf16 v[156:159], v[220:223], v[188:191], v[156:159]
    s_barrier
    s_waitcnt vmcnt(8)
    ds_read_b128 v[160:163], v228 offset:0
    ds_read_b128 v[192:195], v232 offset:18432
    ds_read_b128 v[164:167], v228 offset:2048
    ds_read_b128 v[168:171], v228 offset:4096
    ds_read_b128 v[172:175], v228 offset:6144
    ds_read_b128 v[196:199], v232 offset:19456
    ds_read_b128 v[200:203], v232 offset:20480
    s_waitcnt lgkmcnt(5)
    v_mfma_f32_16x16x32_bf16 v[16:19], v[160:163], v[192:195], v[16:19]
    s_add_u32 m0, s98, 65536
    s_nop 0
    buffer_load_dwordx4 v245, s[16:19], s70 offen lds
    s_waitcnt lgkmcnt(4)
    v_mfma_f32_16x16x32_bf16 v[20:23], v[164:167], v[192:195], v[20:23]
    s_waitcnt lgkmcnt(3)
    v_mfma_f32_16x16x32_bf16 v[24:27], v[168:171], v[192:195], v[24:27]
    s_waitcnt lgkmcnt(2)
    v_mfma_f32_16x16x32_bf16 v[28:31], v[172:175], v[192:195], v[28:31]
    ds_read_b128 v[204:207], v232 offset:21504
    s_waitcnt lgkmcnt(2)
    v_mfma_f32_16x16x32_bf16 v[32:35], v[160:163], v[196:199], v[32:35]
    v_mfma_f32_16x16x32_bf16 v[36:39], v[164:167], v[196:199], v[36:39]
    v_mfma_f32_16x16x32_bf16 v[40:43], v[168:171], v[196:199], v[40:43]
    v_mfma_f32_16x16x32_bf16 v[44:47], v[172:175], v[196:199], v[44:47]
    ds_read_b128 v[208:211], v232 offset:26624
    s_waitcnt lgkmcnt(2)
    v_mfma_f32_16x16x32_bf16 v[48:51], v[160:163], v[200:203], v[48:51]
    v_mfma_f32_16x16x32_bf16 v[52:55], v[164:167], v[200:203], v[52:55]
    buffer_load_dwordx4 v246, s[16:19], s70 offen offset:1024 lds
    v_mfma_f32_16x16x32_bf16 v[56:59], v[168:171], v[200:203], v[56:59]
    v_mfma_f32_16x16x32_bf16 v[60:63], v[172:175], v[200:203], v[60:63]
    ds_read_b128 v[212:215], v232 offset:27648
    s_waitcnt lgkmcnt(2)
    v_mfma_f32_16x16x32_bf16 v[64:67], v[160:163], v[204:207], v[64:67]
    v_mfma_f32_16x16x32_bf16 v[68:71], v[164:167], v[204:207], v[68:71]
    v_mfma_f32_16x16x32_bf16 v[72:75], v[168:171], v[204:207], v[72:75]
    v_mfma_f32_16x16x32_bf16 v[76:79], v[172:175], v[204:207], v[76:79]
    ds_read_b128 v[192:195], v232 offset:28672
    ds_read_b128 v[176:179], v229 offset:0
    s_waitcnt lgkmcnt(3)
    v_mfma_f32_16x16x32_bf16 v[80:83], v[160:163], v[208:211], v[80:83]
    ds_read_b128 v[180:183], v229 offset:2048
    v_mfma_f32_16x16x32_bf16 v[84:87], v[164:167], v[208:211], v[84:87]
    ds_read_b128 v[184:187], v229 offset:4096
    v_mfma_f32_16x16x32_bf16 v[88:91], v[168:171], v[208:211], v[88:91]
    buffer_load_dwordx4 v247, s[16:19], s70 offen offset:2048 lds
    ds_read_b128 v[188:191], v229 offset:6144
    v_mfma_f32_16x16x32_bf16 v[92:95], v[172:175], v[208:211], v[92:95]
    ds_read_b128 v[196:199], v232 offset:29696
    s_waitcnt lgkmcnt(6)
    v_mfma_f32_16x16x32_bf16 v[96:99], v[160:163], v[212:215], v[96:99]
    v_mfma_f32_16x16x32_bf16 v[100:103], v[164:167], v[212:215], v[100:103]
    v_mfma_f32_16x16x32_bf16 v[104:107], v[168:171], v[212:215], v[104:107]
    v_mfma_f32_16x16x32_bf16 v[108:111], v[172:175], v[212:215], v[108:111]
    ds_read_b128 v[216:219], v232 offset:34816
    s_waitcnt lgkmcnt(6)
    v_mfma_f32_16x16x32_bf16 v[112:115], v[160:163], v[192:195], v[112:115]
    v_mfma_f32_16x16x32_bf16 v[116:119], v[164:167], v[192:195], v[116:119]
    v_mfma_f32_16x16x32_bf16 v[120:123], v[168:171], v[192:195], v[120:123]
    v_mfma_f32_16x16x32_bf16 v[124:127], v[172:175], v[192:195], v[124:127]
    buffer_load_dwordx4 v248, s[16:19], s70 offen offset:3072 lds
    ds_read_b128 v[200:203], v232 offset:22528
    s_waitcnt lgkmcnt(2)
    v_mfma_f32_16x16x32_bf16 v[128:131], v[160:163], v[196:199], v[128:131]
    v_mfma_f32_16x16x32_bf16 v[132:135], v[164:167], v[196:199], v[132:135]
    v_mfma_f32_16x16x32_bf16 v[136:139], v[168:171], v[196:199], v[136:139]
    v_mfma_f32_16x16x32_bf16 v[140:143], v[172:175], v[196:199], v[140:143]
    ds_read_b128 v[204:207], v232 offset:23552
    s_waitcnt lgkmcnt(2)
    v_mfma_f32_16x16x32_bf16 v[144:147], v[216:219], v[160:163], v[144:147]
    v_mfma_f32_16x16x32_bf16 v[148:151], v[216:219], v[164:167], v[148:151]
    v_mfma_f32_16x16x32_bf16 v[152:155], v[216:219], v[168:171], v[152:155]
    v_mfma_f32_16x16x32_bf16 v[156:159], v[216:219], v[172:175], v[156:159]
    s_add_u32 m0, s98, 69632
    ds_read_b128 v[208:211], v232 offset:24576
    s_waitcnt lgkmcnt(2)
    v_mfma_f32_16x16x32_bf16 v[16:19], v[176:179], v[200:203], v[16:19]
    buffer_load_dwordx4 v245, s[16:19], s71 offen lds
    v_mfma_f32_16x16x32_bf16 v[20:23], v[180:183], v[200:203], v[20:23]
    v_mfma_f32_16x16x32_bf16 v[24:27], v[184:187], v[200:203], v[24:27]
    v_mfma_f32_16x16x32_bf16 v[28:31], v[188:191], v[200:203], v[28:31]
    ds_read_b128 v[212:215], v232 offset:25600
    s_waitcnt lgkmcnt(2)
    v_mfma_f32_16x16x32_bf16 v[32:35], v[176:179], v[204:207], v[32:35]
    v_mfma_f32_16x16x32_bf16 v[36:39], v[180:183], v[204:207], v[36:39]
    v_mfma_f32_16x16x32_bf16 v[40:43], v[184:187], v[204:207], v[40:43]
    v_mfma_f32_16x16x32_bf16 v[44:47], v[188:191], v[204:207], v[44:47]
    ds_read_b128 v[192:195], v232 offset:30720
    s_waitcnt lgkmcnt(2)
    v_mfma_f32_16x16x32_bf16 v[48:51], v[176:179], v[208:211], v[48:51]
    v_mfma_f32_16x16x32_bf16 v[52:55], v[180:183], v[208:211], v[52:55]
    buffer_load_dwordx4 v246, s[16:19], s71 offen offset:1024 lds
    v_mfma_f32_16x16x32_bf16 v[56:59], v[184:187], v[208:211], v[56:59]
    v_mfma_f32_16x16x32_bf16 v[60:63], v[188:191], v[208:211], v[60:63]
    ds_read_b128 v[196:199], v232 offset:31744
    s_waitcnt lgkmcnt(2)
    v_mfma_f32_16x16x32_bf16 v[64:67], v[176:179], v[212:215], v[64:67]
    v_mfma_f32_16x16x32_bf16 v[68:71], v[180:183], v[212:215], v[68:71]
    v_mfma_f32_16x16x32_bf16 v[72:75], v[184:187], v[212:215], v[72:75]
    v_mfma_f32_16x16x32_bf16 v[76:79], v[188:191], v[212:215], v[76:79]
    ds_read_b128 v[200:203], v232 offset:32768
    s_waitcnt lgkmcnt(2)
    v_mfma_f32_16x16x32_bf16 v[80:83], v[176:179], v[192:195], v[80:83]
    v_mfma_f32_16x16x32_bf16 v[84:87], v[180:183], v[192:195], v[84:87]
    v_mfma_f32_16x16x32_bf16 v[88:91], v[184:187], v[192:195], v[88:91]
    buffer_load_dwordx4 v247, s[16:19], s71 offen offset:2048 lds
    v_mfma_f32_16x16x32_bf16 v[92:95], v[188:191], v[192:195], v[92:95]
    ds_read_b128 v[204:207], v232 offset:33792
    s_waitcnt lgkmcnt(2)
    v_mfma_f32_16x16x32_bf16 v[96:99], v[176:179], v[196:199], v[96:99]
    v_mfma_f32_16x16x32_bf16 v[100:103], v[180:183], v[196:199], v[100:103]
    v_mfma_f32_16x16x32_bf16 v[104:107], v[184:187], v[196:199], v[104:107]
    v_mfma_f32_16x16x32_bf16 v[108:111], v[188:191], v[196:199], v[108:111]
    ds_read_b128 v[220:223], v232 offset:35840
    s_waitcnt lgkmcnt(2)
    v_mfma_f32_16x16x32_bf16 v[112:115], v[176:179], v[200:203], v[112:115]
    v_mfma_f32_16x16x32_bf16 v[116:119], v[180:183], v[200:203], v[116:119]
    v_mfma_f32_16x16x32_bf16 v[120:123], v[184:187], v[200:203], v[120:123]
    v_mfma_f32_16x16x32_bf16 v[124:127], v[188:191], v[200:203], v[124:127]
    buffer_load_dwordx4 v248, s[16:19], s71 offen offset:3072 lds
    s_waitcnt lgkmcnt(1)
    v_mfma_f32_16x16x32_bf16 v[128:131], v[176:179], v[204:207], v[128:131]
    v_mfma_f32_16x16x32_bf16 v[132:135], v[180:183], v[204:207], v[132:135]
    v_mfma_f32_16x16x32_bf16 v[136:139], v[184:187], v[204:207], v[136:139]
    v_mfma_f32_16x16x32_bf16 v[140:143], v[188:191], v[204:207], v[140:143]
    s_waitcnt lgkmcnt(0)
    v_mfma_f32_16x16x32_bf16 v[144:147], v[220:223], v[176:179], v[144:147]
    v_mfma_f32_16x16x32_bf16 v[148:151], v[220:223], v[180:183], v[148:151]
    v_mfma_f32_16x16x32_bf16 v[152:155], v[220:223], v[184:187], v[152:155]
    v_mfma_f32_16x16x32_bf16 v[156:159], v[220:223], v[188:191], v[156:159]
    s_barrier
    s_waitcnt vmcnt(8)
    ds_read_b128 v[160:163], v228 offset:32768
    ds_read_b128 v[208:211], v232 offset:0
    ds_read_b128 v[164:167], v228 offset:34816
    ds_read_b128 v[168:171], v228 offset:36864
    ds_read_b128 v[172:175], v228 offset:38912
    ds_read_b128 v[212:215], v232 offset:1024
    ds_read_b128 v[192:195], v232 offset:2048
    s_waitcnt lgkmcnt(5)
    v_mfma_f32_16x16x32_bf16 v[16:19], v[160:163], v[208:211], v[16:19]
    s_add_u32 m0, s98, 0
    s_nop 0
    buffer_load_dwordx4 v245, s[16:19], s72 offen lds
    s_waitcnt lgkmcnt(4)
    v_mfma_f32_16x16x32_bf16 v[20:23], v[164:167], v[208:211], v[20:23]
    s_waitcnt lgkmcnt(3)
    v_mfma_f32_16x16x32_bf16 v[24:27], v[168:171], v[208:211], v[24:27]
    s_waitcnt lgkmcnt(2)
    v_mfma_f32_16x16x32_bf16 v[28:31], v[172:175], v[208:211], v[28:31]
    ds_read_b128 v[196:199], v232 offset:3072
    s_waitcnt lgkmcnt(2)
    v_mfma_f32_16x16x32_bf16 v[32:35], v[160:163], v[212:215], v[32:35]
    v_mfma_f32_16x16x32_bf16 v[36:39], v[164:167], v[212:215], v[36:39]
    v_mfma_f32_16x16x32_bf16 v[40:43], v[168:171], v[212:215], v[40:43]
    v_mfma_f32_16x16x32_bf16 v[44:47], v[172:175], v[212:215], v[44:47]
    ds_read_b128 v[200:203], v232 offset:8192
    s_waitcnt lgkmcnt(2)
    v_mfma_f32_16x16x32_bf16 v[48:51], v[160:163], v[192:195], v[48:51]
    v_mfma_f32_16x16x32_bf16 v[52:55], v[164:167], v[192:195], v[52:55]
    buffer_load_dwordx4 v246, s[16:19], s72 offen offset:1024 lds
    v_mfma_f32_16x16x32_bf16 v[56:59], v[168:171], v[192:195], v[56:59]
    v_mfma_f32_16x16x32_bf16 v[60:63], v[172:175], v[192:195], v[60:63]
    ds_read_b128 v[204:207], v232 offset:9216
    s_waitcnt lgkmcnt(2)
    v_mfma_f32_16x16x32_bf16 v[64:67], v[160:163], v[196:199], v[64:67]
    v_mfma_f32_16x16x32_bf16 v[68:71], v[164:167], v[196:199], v[68:71]
    v_mfma_f32_16x16x32_bf16 v[72:75], v[168:171], v[196:199], v[72:75]
    v_mfma_f32_16x16x32_bf16 v[76:79], v[172:175], v[196:199], v[76:79]
    ds_read_b128 v[208:211], v232 offset:10240
    ds_read_b128 v[176:179], v229 offset:32768
    s_waitcnt lgkmcnt(3)
    v_mfma_f32_16x16x32_bf16 v[80:83], v[160:163], v[200:203], v[80:83]
    ds_read_b128 v[180:183], v229 offset:34816
    v_mfma_f32_16x16x32_bf16 v[84:87], v[164:167], v[200:203], v[84:87]
    ds_read_b128 v[184:187], v229 offset:36864
    v_mfma_f32_16x16x32_bf16 v[88:91], v[168:171], v[200:203], v[88:91]
    buffer_load_dwordx4 v247, s[16:19], s72 offen offset:2048 lds
    ds_read_b128 v[188:191], v229 offset:38912
    v_mfma_f32_16x16x32_bf16 v[92:95], v[172:175], v[200:203], v[92:95]
    ds_read_b128 v[212:215], v232 offset:11264
    s_waitcnt lgkmcnt(6)
    v_mfma_f32_16x16x32_bf16 v[96:99], v[160:163], v[204:207], v[96:99]
    v_mfma_f32_16x16x32_bf16 v[100:103], v[164:167], v[204:207], v[100:103]
    v_mfma_f32_16x16x32_bf16 v[104:107], v[168:171], v[204:207], v[104:107]
    v_mfma_f32_16x16x32_bf16 v[108:111], v[172:175], v[204:207], v[108:111]
    ds_read_b128 v[216:219], v232 offset:16384
    s_waitcnt lgkmcnt(6)
    v_mfma_f32_16x16x32_bf16 v[112:115], v[160:163], v[208:211], v[112:115]
    v_mfma_f32_16x16x32_bf16 v[116:119], v[164:167], v[208:211], v[116:119]
    v_mfma_f32_16x16x32_bf16 v[120:123], v[168:171], v[208:211], v[120:123]
    v_mfma_f32_16x16x32_bf16 v[124:127], v[172:175], v[208:211], v[124:127]
    buffer_load_dwordx4 v248, s[16:19], s72 offen offset:3072 lds
    ds_read_b128 v[192:195], v232 offset:4096
    s_waitcnt lgkmcnt(2)
    v_mfma_f32_16x16x32_bf16 v[128:131], v[160:163], v[212:215], v[128:131]
    v_mfma_f32_16x16x32_bf16 v[132:135], v[164:167], v[212:215], v[132:135]
    v_mfma_f32_16x16x32_bf16 v[136:139], v[168:171], v[212:215], v[136:139]
    v_mfma_f32_16x16x32_bf16 v[140:143], v[172:175], v[212:215], v[140:143]
    ds_read_b128 v[196:199], v232 offset:5120
    s_waitcnt lgkmcnt(2)
    v_mfma_f32_16x16x32_bf16 v[144:147], v[216:219], v[160:163], v[144:147]
    v_mfma_f32_16x16x32_bf16 v[148:151], v[216:219], v[164:167], v[148:151]
    v_mfma_f32_16x16x32_bf16 v[152:155], v[216:219], v[168:171], v[152:155]
    v_mfma_f32_16x16x32_bf16 v[156:159], v[216:219], v[172:175], v[156:159]
    s_add_u32 m0, s98, 4096
    ds_read_b128 v[200:203], v232 offset:6144
    s_waitcnt lgkmcnt(2)
    v_mfma_f32_16x16x32_bf16 v[16:19], v[176:179], v[192:195], v[16:19]
    buffer_load_dwordx4 v245, s[16:19], s73 offen lds
    v_mfma_f32_16x16x32_bf16 v[20:23], v[180:183], v[192:195], v[20:23]
    v_mfma_f32_16x16x32_bf16 v[24:27], v[184:187], v[192:195], v[24:27]
    v_mfma_f32_16x16x32_bf16 v[28:31], v[188:191], v[192:195], v[28:31]
    ds_read_b128 v[204:207], v232 offset:7168
    s_waitcnt lgkmcnt(2)
    v_mfma_f32_16x16x32_bf16 v[32:35], v[176:179], v[196:199], v[32:35]
    v_mfma_f32_16x16x32_bf16 v[36:39], v[180:183], v[196:199], v[36:39]
    v_mfma_f32_16x16x32_bf16 v[40:43], v[184:187], v[196:199], v[40:43]
    v_mfma_f32_16x16x32_bf16 v[44:47], v[188:191], v[196:199], v[44:47]
    ds_read_b128 v[208:211], v232 offset:12288
    s_waitcnt lgkmcnt(2)
    v_mfma_f32_16x16x32_bf16 v[48:51], v[176:179], v[200:203], v[48:51]
    v_mfma_f32_16x16x32_bf16 v[52:55], v[180:183], v[200:203], v[52:55]
    buffer_load_dwordx4 v246, s[16:19], s73 offen offset:1024 lds
    v_mfma_f32_16x16x32_bf16 v[56:59], v[184:187], v[200:203], v[56:59]
    v_mfma_f32_16x16x32_bf16 v[60:63], v[188:191], v[200:203], v[60:63]
    ds_read_b128 v[212:215], v232 offset:13312
    s_waitcnt lgkmcnt(2)
    v_mfma_f32_16x16x32_bf16 v[64:67], v[176:179], v[204:207], v[64:67]
    v_mfma_f32_16x16x32_bf16 v[68:71], v[180:183], v[204:207], v[68:71]
    v_mfma_f32_16x16x32_bf16 v[72:75], v[184:187], v[204:207], v[72:75]
    v_mfma_f32_16x16x32_bf16 v[76:79], v[188:191], v[204:207], v[76:79]
    ds_read_b128 v[192:195], v232 offset:14336
    s_waitcnt lgkmcnt(2)
    v_mfma_f32_16x16x32_bf16 v[80:83], v[176:179], v[208:211], v[80:83]
    v_mfma_f32_16x16x32_bf16 v[84:87], v[180:183], v[208:211], v[84:87]
    v_mfma_f32_16x16x32_bf16 v[88:91], v[184:187], v[208:211], v[88:91]
    buffer_load_dwordx4 v247, s[16:19], s73 offen offset:2048 lds
    v_mfma_f32_16x16x32_bf16 v[92:95], v[188:191], v[208:211], v[92:95]
    ds_read_b128 v[196:199], v232 offset:15360
    s_waitcnt lgkmcnt(2)
    v_mfma_f32_16x16x32_bf16 v[96:99], v[176:179], v[212:215], v[96:99]
    v_mfma_f32_16x16x32_bf16 v[100:103], v[180:183], v[212:215], v[100:103]
    v_mfma_f32_16x16x32_bf16 v[104:107], v[184:187], v[212:215], v[104:107]
    v_mfma_f32_16x16x32_bf16 v[108:111], v[188:191], v[212:215], v[108:111]
    ds_read_b128 v[220:223], v232 offset:17408
    s_waitcnt lgkmcnt(2)
    v_mfma_f32_16x16x32_bf16 v[112:115], v[176:179], v[192:195], v[112:115]
    v_mfma_f32_16x16x32_bf16 v[116:119], v[180:183], v[192:195], v[116:119]
    v_mfma_f32_16x16x32_bf16 v[120:123], v[184:187], v[192:195], v[120:123]
    v_mfma_f32_16x16x32_bf16 v[124:127], v[188:191], v[192:195], v[124:127]
    buffer_load_dwordx4 v248, s[16:19], s73 offen offset:3072 lds
    s_waitcnt lgkmcnt(1)
    v_mfma_f32_16x16x32_bf16 v[128:131], v[176:179], v[196:199], v[128:131]
    v_mfma_f32_16x16x32_bf16 v[132:135], v[180:183], v[196:199], v[132:135]
    v_mfma_f32_16x16x32_bf16 v[136:139], v[184:187], v[196:199], v[136:139]
    v_mfma_f32_16x16x32_bf16 v[140:143], v[188:191], v[196:199], v[140:143]
    s_waitcnt lgkmcnt(0)
    v_mfma_f32_16x16x32_bf16 v[144:147], v[220:223], v[176:179], v[144:147]
    v_mfma_f32_16x16x32_bf16 v[148:151], v[220:223], v[180:183], v[148:151]
    v_mfma_f32_16x16x32_bf16 v[152:155], v[220:223], v[184:187], v[152:155]
    v_mfma_f32_16x16x32_bf16 v[156:159], v[220:223], v[188:191], v[156:159]
    s_barrier
    s_waitcnt vmcnt(8)
    ds_read_b128 v[160:163], v230 offset:0
    ds_read_b128 v[200:203], v232 offset:18432
    ds_read_b128 v[164:167], v230 offset:2048
    ds_read_b128 v[168:171], v230 offset:4096
    ds_read_b128 v[172:175], v230 offset:6144
    ds_read_b128 v[204:207], v232 offset:19456
    ds_read_b128 v[208:211], v232 offset:20480
    s_waitcnt lgkmcnt(5)
    v_mfma_f32_16x16x32_bf16 v[16:19], v[160:163], v[200:203], v[16:19]
    s_add_u32 m0, s98, 32768
    s_nop 0
    buffer_load_dwordx4 v245, s[16:19], s74 offen lds
    s_waitcnt lgkmcnt(4)
    v_mfma_f32_16x16x32_bf16 v[20:23], v[164:167], v[200:203], v[20:23]
    s_waitcnt lgkmcnt(3)
    v_mfma_f32_16x16x32_bf16 v[24:27], v[168:171], v[200:203], v[24:27]
    s_waitcnt lgkmcnt(2)
    v_mfma_f32_16x16x32_bf16 v[28:31], v[172:175], v[200:203], v[28:31]
    ds_read_b128 v[212:215], v232 offset:21504
    s_waitcnt lgkmcnt(2)
    v_mfma_f32_16x16x32_bf16 v[32:35], v[160:163], v[204:207], v[32:35]
    v_mfma_f32_16x16x32_bf16 v[36:39], v[164:167], v[204:207], v[36:39]
    v_mfma_f32_16x16x32_bf16 v[40:43], v[168:171], v[204:207], v[40:43]
    v_mfma_f32_16x16x32_bf16 v[44:47], v[172:175], v[204:207], v[44:47]
    ds_read_b128 v[192:195], v232 offset:26624
    s_waitcnt lgkmcnt(2)
    v_mfma_f32_16x16x32_bf16 v[48:51], v[160:163], v[208:211], v[48:51]
    v_mfma_f32_16x16x32_bf16 v[52:55], v[164:167], v[208:211], v[52:55]
    buffer_load_dwordx4 v246, s[16:19], s74 offen offset:1024 lds
    v_mfma_f32_16x16x32_bf16 v[56:59], v[168:171], v[208:211], v[56:59]
    v_mfma_f32_16x16x32_bf16 v[60:63], v[172:175], v[208:211], v[60:63]
    ds_read_b128 v[196:199], v232 offset:27648
    s_waitcnt lgkmcnt(2)
    v_mfma_f32_16x16x32_bf16 v[64:67], v[160:163], v[212:215], v[64:67]
    v_mfma_f32_16x16x32_bf16 v[68:71], v[164:167], v[212:215], v[68:71]
    v_mfma_f32_16x16x32_bf16 v[72:75], v[168:171], v[212:215], v[72:75]
    v_mfma_f32_16x16x32_bf16 v[76:79], v[172:175], v[212:215], v[76:79]
    ds_read_b128 v[200:203], v232 offset:28672
    ds_read_b128 v[176:179], v231 offset:0
    s_waitcnt lgkmcnt(3)
    v_mfma_f32_16x16x32_bf16 v[80:83], v[160:163], v[192:195], v[80:83]
    ds_read_b128 v[180:183], v231 offset:2048
    v_mfma_f32_16x16x32_bf16 v[84:87], v[164:167], v[192:195], v[84:87]
    ds_read_b128 v[184:187], v231 offset:4096
    v_mfma_f32_16x16x32_bf16 v[88:91], v[168:171], v[192:195], v[88:91]
    buffer_load_dwordx4 v247, s[16:19], s74 offen offset:2048 lds
    ds_read_b128 v[188:191], v231 offset:6144
    v_mfma_f32_16x16x32_bf16 v[92:95], v[172:175], v[192:195], v[92:95]
    ds_read_b128 v[204:207], v232 offset:29696
    s_waitcnt lgkmcnt(6)
    v_mfma_f32_16x16x32_bf16 v[96:99], v[160:163], v[196:199], v[96:99]
    v_mfma_f32_16x16x32_bf16 v[100:103], v[164:167], v[196:199], v[100:103]
    v_mfma_f32_16x16x32_bf16 v[104:107], v[168:171], v[196:199], v[104:107]
    v_mfma_f32_16x16x32_bf16 v[108:111], v[172:175], v[196:199], v[108:111]
    ds_read_b128 v[216:219], v232 offset:34816
    s_waitcnt lgkmcnt(6)
    v_mfma_f32_16x16x32_bf16 v[112:115], v[160:163], v[200:203], v[112:115]
    v_mfma_f32_16x16x32_bf16 v[116:119], v[164:167], v[200:203], v[116:119]
    v_mfma_f32_16x16x32_bf16 v[120:123], v[168:171], v[200:203], v[120:123]
    v_mfma_f32_16x16x32_bf16 v[124:127], v[172:175], v[200:203], v[124:127]
    buffer_load_dwordx4 v248, s[16:19], s74 offen offset:3072 lds
    ds_read_b128 v[208:211], v232 offset:22528
    s_waitcnt lgkmcnt(2)
    v_mfma_f32_16x16x32_bf16 v[128:131], v[160:163], v[204:207], v[128:131]
    v_mfma_f32_16x16x32_bf16 v[132:135], v[164:167], v[204:207], v[132:135]
    v_mfma_f32_16x16x32_bf16 v[136:139], v[168:171], v[204:207], v[136:139]
    v_mfma_f32_16x16x32_bf16 v[140:143], v[172:175], v[204:207], v[140:143]
    ds_read_b128 v[212:215], v232 offset:23552
    s_waitcnt lgkmcnt(2)
    v_mfma_f32_16x16x32_bf16 v[144:147], v[216:219], v[160:163], v[144:147]
    v_mfma_f32_16x16x32_bf16 v[148:151], v[216:219], v[164:167], v[148:151]
    v_mfma_f32_16x16x32_bf16 v[152:155], v[216:219], v[168:171], v[152:155]
    v_mfma_f32_16x16x32_bf16 v[156:159], v[216:219], v[172:175], v[156:159]
    s_add_u32 m0, s98, 36864
    ds_read_b128 v[192:195], v232 offset:24576
    s_waitcnt lgkmcnt(2)
    v_mfma_f32_16x16x32_bf16 v[16:19], v[176:179], v[208:211], v[16:19]
    buffer_load_dwordx4 v245, s[16:19], s75 offen lds
    v_mfma_f32_16x16x32_bf16 v[20:23], v[180:183], v[208:211], v[20:23]
    v_mfma_f32_16x16x32_bf16 v[24:27], v[184:187], v[208:211], v[24:27]
    v_mfma_f32_16x16x32_bf16 v[28:31], v[188:191], v[208:211], v[28:31]
    ds_read_b128 v[196:199], v232 offset:25600
    s_waitcnt lgkmcnt(2)
    v_mfma_f32_16x16x32_bf16 v[32:35], v[176:179], v[212:215], v[32:35]
    v_mfma_f32_16x16x32_bf16 v[36:39], v[180:183], v[212:215], v[36:39]
    v_mfma_f32_16x16x32_bf16 v[40:43], v[184:187], v[212:215], v[40:43]
    v_mfma_f32_16x16x32_bf16 v[44:47], v[188:191], v[212:215], v[44:47]
    ds_read_b128 v[200:203], v232 offset:30720
    s_waitcnt lgkmcnt(2)
    v_mfma_f32_16x16x32_bf16 v[48:51], v[176:179], v[192:195], v[48:51]
    v_mfma_f32_16x16x32_bf16 v[52:55], v[180:183], v[192:195], v[52:55]
    buffer_load_dwordx4 v246, s[16:19], s75 offen offset:1024 lds
    v_mfma_f32_16x16x32_bf16 v[56:59], v[184:187], v[192:195], v[56:59]
    v_mfma_f32_16x16x32_bf16 v[60:63], v[188:191], v[192:195], v[60:63]
    ds_read_b128 v[204:207], v232 offset:31744
    s_waitcnt lgkmcnt(2)
    v_mfma_f32_16x16x32_bf16 v[64:67], v[176:179], v[196:199], v[64:67]
    v_mfma_f32_16x16x32_bf16 v[68:71], v[180:183], v[196:199], v[68:71]
    v_mfma_f32_16x16x32_bf16 v[72:75], v[184:187], v[196:199], v[72:75]
    v_mfma_f32_16x16x32_bf16 v[76:79], v[188:191], v[196:199], v[76:79]
    ds_read_b128 v[208:211], v232 offset:32768
    s_waitcnt lgkmcnt(2)
    v_mfma_f32_16x16x32_bf16 v[80:83], v[176:179], v[200:203], v[80:83]
    v_mfma_f32_16x16x32_bf16 v[84:87], v[180:183], v[200:203], v[84:87]
    v_mfma_f32_16x16x32_bf16 v[88:91], v[184:187], v[200:203], v[88:91]
    buffer_load_dwordx4 v247, s[16:19], s75 offen offset:2048 lds
    v_mfma_f32_16x16x32_bf16 v[92:95], v[188:191], v[200:203], v[92:95]
    ds_read_b128 v[212:215], v232 offset:33792
    s_waitcnt lgkmcnt(2)
    v_mfma_f32_16x16x32_bf16 v[96:99], v[176:179], v[204:207], v[96:99]
    v_mfma_f32_16x16x32_bf16 v[100:103], v[180:183], v[204:207], v[100:103]
    v_mfma_f32_16x16x32_bf16 v[104:107], v[184:187], v[204:207], v[104:107]
    v_mfma_f32_16x16x32_bf16 v[108:111], v[188:191], v[204:207], v[108:111]
    ds_read_b128 v[220:223], v232 offset:35840
    s_waitcnt lgkmcnt(2)
    v_mfma_f32_16x16x32_bf16 v[112:115], v[176:179], v[208:211], v[112:115]
    v_mfma_f32_16x16x32_bf16 v[116:119], v[180:183], v[208:211], v[116:119]
    v_mfma_f32_16x16x32_bf16 v[120:123], v[184:187], v[208:211], v[120:123]
    v_mfma_f32_16x16x32_bf16 v[124:127], v[188:191], v[208:211], v[124:127]
    buffer_load_dwordx4 v248, s[16:19], s75 offen offset:3072 lds
    s_waitcnt lgkmcnt(1)
    v_mfma_f32_16x16x32_bf16 v[128:131], v[176:179], v[212:215], v[128:131]
    v_mfma_f32_16x16x32_bf16 v[132:135], v[180:183], v[212:215], v[132:135]
    v_mfma_f32_16x16x32_bf16 v[136:139], v[184:187], v[212:215], v[136:139]
    v_mfma_f32_16x16x32_bf16 v[140:143], v[188:191], v[212:215], v[140:143]
    s_waitcnt lgkmcnt(0)
    v_mfma_f32_16x16x32_bf16 v[144:147], v[220:223], v[176:179], v[144:147]
    v_mfma_f32_16x16x32_bf16 v[148:151], v[220:223], v[180:183], v[148:151]
    v_mfma_f32_16x16x32_bf16 v[152:155], v[220:223], v[184:187], v[152:155]
    v_mfma_f32_16x16x32_bf16 v[156:159], v[220:223], v[188:191], v[156:159]
    s_barrier
    s_waitcnt vmcnt(8)
    ds_read_b128 v[160:163], v228 offset:0
    ds_read_b128 v[192:195], v232 offset:0
    ds_read_b128 v[164:167], v228 offset:2048
    ds_read_b128 v[168:171], v228 offset:4096
    ds_read_b128 v[172:175], v228 offset:6144
    ds_read_b128 v[196:199], v232 offset:1024
    ds_read_b128 v[200:203], v232 offset:2048
    s_waitcnt lgkmcnt(5)
    v_mfma_f32_16x16x32_bf16 v[16:19], v[160:163], v[192:195], v[16:19]
    s_add_u32 m0, s98, 65536
    s_nop 0
    buffer_load_dwordx4 v245, s[16:19], s76 offen lds
    s_waitcnt lgkmcnt(4)
    v_mfma_f32_16x16x32_bf16 v[20:23], v[164:167], v[192:195], v[20:23]
    s_waitcnt lgkmcnt(3)
    v_mfma_f32_16x16x32_bf16 v[24:27], v[168:171], v[192:195], v[24:27]
    s_waitcnt lgkmcnt(2)
    v_mfma_f32_16x16x32_bf16 v[28:31], v[172:175], v[192:195], v[28:31]
    ds_read_b128 v[204:207], v232 offset:3072
    s_waitcnt lgkmcnt(2)
    v_mfma_f32_16x16x32_bf16 v[32:35], v[160:163], v[196:199], v[32:35]
    v_mfma_f32_16x16x32_bf16 v[36:39], v[164:167], v[196:199], v[36:39]
    v_mfma_f32_16x16x32_bf16 v[40:43], v[168:171], v[196:199], v[40:43]
    v_mfma_f32_16x16x32_bf16 v[44:47], v[172:175], v[196:199], v[44:47]
    ds_read_b128 v[208:211], v232 offset:8192
    s_waitcnt lgkmcnt(2)
    v_mfma_f32_16x16x32_bf16 v[48:51], v[160:163], v[200:203], v[48:51]
    v_mfma_f32_16x16x32_bf16 v[52:55], v[164:167], v[200:203], v[52:55]
    buffer_load_dwordx4 v246, s[16:19], s76 offen offset:1024 lds
    v_mfma_f32_16x16x32_bf16 v[56:59], v[168:171], v[200:203], v[56:59]
    v_mfma_f32_16x16x32_bf16 v[60:63], v[172:175], v[200:203], v[60:63]
    ds_read_b128 v[212:215], v232 offset:9216
    s_waitcnt lgkmcnt(2)
    v_mfma_f32_16x16x32_bf16 v[64:67], v[160:163], v[204:207], v[64:67]
    v_mfma_f32_16x16x32_bf16 v[68:71], v[164:167], v[204:207], v[68:71]
    v_mfma_f32_16x16x32_bf16 v[72:75], v[168:171], v[204:207], v[72:75]
    v_mfma_f32_16x16x32_bf16 v[76:79], v[172:175], v[204:207], v[76:79]
    ds_read_b128 v[192:195], v232 offset:10240
    ds_read_b128 v[176:179], v229 offset:0
    s_waitcnt lgkmcnt(3)
    v_mfma_f32_16x16x32_bf16 v[80:83], v[160:163], v[208:211], v[80:83]
    ds_read_b128 v[180:183], v229 offset:2048
    v_mfma_f32_16x16x32_bf16 v[84:87], v[164:167], v[208:211], v[84:87]
    ds_read_b128 v[184:187], v229 offset:4096
    v_mfma_f32_16x16x32_bf16 v[88:91], v[168:171], v[208:211], v[88:91]
    buffer_load_dwordx4 v247, s[16:19], s76 offen offset:2048 lds
    ds_read_b128 v[188:191], v229 offset:6144
    v_mfma_f32_16x16x32_bf16 v[92:95], v[172:175], v[208:211], v[92:95]
    ds_read_b128 v[196:199], v232 offset:11264
    s_waitcnt lgkmcnt(6)
    v_mfma_f32_16x16x32_bf16 v[96:99], v[160:163], v[212:215], v[96:99]
    v_mfma_f32_16x16x32_bf16 v[100:103], v[164:167], v[212:215], v[100:103]
    v_mfma_f32_16x16x32_bf16 v[104:107], v[168:171], v[212:215], v[104:107]
    v_mfma_f32_16x16x32_bf16 v[108:111], v[172:175], v[212:215], v[108:111]
    ds_read_b128 v[216:219], v232 offset:16384
    s_waitcnt lgkmcnt(6)
    v_mfma_f32_16x16x32_bf16 v[112:115], v[160:163], v[192:195], v[112:115]
    v_mfma_f32_16x16x32_bf16 v[116:119], v[164:167], v[192:195], v[116:119]
    v_mfma_f32_16x16x32_bf16 v[120:123], v[168:171], v[192:195], v[120:123]
    v_mfma_f32_16x16x32_bf16 v[124:127], v[172:175], v[192:195], v[124:127]
    buffer_load_dwordx4 v248, s[16:19], s76 offen offset:3072 lds
    ds_read_b128 v[200:203], v232 offset:4096
    s_waitcnt lgkmcnt(2)
    v_mfma_f32_16x16x32_bf16 v[128:131], v[160:163], v[196:199], v[128:131]
    v_mfma_f32_16x16x32_bf16 v[132:135], v[164:167], v[196:199], v[132:135]
    v_mfma_f32_16x16x32_bf16 v[136:139], v[168:171], v[196:199], v[136:139]
    v_mfma_f32_16x16x32_bf16 v[140:143], v[172:175], v[196:199], v[140:143]
    ds_read_b128 v[204:207], v232 offset:5120
    s_waitcnt lgkmcnt(2)
    v_mfma_f32_16x16x32_bf16 v[144:147], v[216:219], v[160:163], v[144:147]
    v_mfma_f32_16x16x32_bf16 v[148:151], v[216:219], v[164:167], v[148:151]
    v_mfma_f32_16x16x32_bf16 v[152:155], v[216:219], v[168:171], v[152:155]
    v_mfma_f32_16x16x32_bf16 v[156:159], v[216:219], v[172:175], v[156:159]
    s_add_u32 m0, s98, 69632
    ds_read_b128 v[208:211], v232 offset:6144
    s_waitcnt lgkmcnt(2)
    v_mfma_f32_16x16x32_bf16 v[16:19], v[176:179], v[200:203], v[16:19]
    buffer_load_dwordx4 v245, s[16:19], s77 offen lds
    v_mfma_f32_16x16x32_bf16 v[20:23], v[180:183], v[200:203], v[20:23]
    v_mfma_f32_16x16x32_bf16 v[24:27], v[184:187], v[200:203], v[24:27]
    v_mfma_f32_16x16x32_bf16 v[28:31], v[188:191], v[200:203], v[28:31]
    ds_read_b128 v[212:215], v232 offset:7168
    s_waitcnt lgkmcnt(2)
    v_mfma_f32_16x16x32_bf16 v[32:35], v[176:179], v[204:207], v[32:35]
    v_mfma_f32_16x16x32_bf16 v[36:39], v[180:183], v[204:207], v[36:39]
    v_mfma_f32_16x16x32_bf16 v[40:43], v[184:187], v[204:207], v[40:43]
    v_mfma_f32_16x16x32_bf16 v[44:47], v[188:191], v[204:207], v[44:47]
    ds_read_b128 v[192:195], v232 offset:12288
    s_waitcnt lgkmcnt(2)
    v_mfma_f32_16x16x32_bf16 v[48:51], v[176:179], v[208:211], v[48:51]
    v_mfma_f32_16x16x32_bf16 v[52:55], v[180:183], v[208:211], v[52:55]
    buffer_load_dwordx4 v246, s[16:19], s77 offen offset:1024 lds
    v_mfma_f32_16x16x32_bf16 v[56:59], v[184:187], v[208:211], v[56:59]
    v_mfma_f32_16x16x32_bf16 v[60:63], v[188:191], v[208:211], v[60:63]
    ds_read_b128 v[196:199], v232 offset:13312
    s_waitcnt lgkmcnt(2)
    v_mfma_f32_16x16x32_bf16 v[64:67], v[176:179], v[212:215], v[64:67]
    v_mfma_f32_16x16x32_bf16 v[68:71], v[180:183], v[212:215], v[68:71]
    v_mfma_f32_16x16x32_bf16 v[72:75], v[184:187], v[212:215], v[72:75]
    v_mfma_f32_16x16x32_bf16 v[76:79], v[188:191], v[212:215], v[76:79]
    ds_read_b128 v[200:203], v232 offset:14336
    s_waitcnt lgkmcnt(2)
    v_mfma_f32_16x16x32_bf16 v[80:83], v[176:179], v[192:195], v[80:83]
    v_mfma_f32_16x16x32_bf16 v[84:87], v[180:183], v[192:195], v[84:87]
    v_mfma_f32_16x16x32_bf16 v[88:91], v[184:187], v[192:195], v[88:91]
    buffer_load_dwordx4 v247, s[16:19], s77 offen offset:2048 lds
    v_mfma_f32_16x16x32_bf16 v[92:95], v[188:191], v[192:195], v[92:95]
    ds_read_b128 v[204:207], v232 offset:15360
    s_waitcnt lgkmcnt(2)
    v_mfma_f32_16x16x32_bf16 v[96:99], v[176:179], v[196:199], v[96:99]
    v_mfma_f32_16x16x32_bf16 v[100:103], v[180:183], v[196:199], v[100:103]
    v_mfma_f32_16x16x32_bf16 v[104:107], v[184:187], v[196:199], v[104:107]
    v_mfma_f32_16x16x32_bf16 v[108:111], v[188:191], v[196:199], v[108:111]
    ds_read_b128 v[220:223], v232 offset:17408
    s_waitcnt lgkmcnt(2)
    v_mfma_f32_16x16x32_bf16 v[112:115], v[176:179], v[200:203], v[112:115]
    v_mfma_f32_16x16x32_bf16 v[116:119], v[180:183], v[200:203], v[116:119]
    v_mfma_f32_16x16x32_bf16 v[120:123], v[184:187], v[200:203], v[120:123]
    v_mfma_f32_16x16x32_bf16 v[124:127], v[188:191], v[200:203], v[124:127]
    buffer_load_dwordx4 v248, s[16:19], s77 offen offset:3072 lds
    s_waitcnt lgkmcnt(1)
    v_mfma_f32_16x16x32_bf16 v[128:131], v[176:179], v[204:207], v[128:131]
    v_mfma_f32_16x16x32_bf16 v[132:135], v[180:183], v[204:207], v[132:135]
    v_mfma_f32_16x16x32_bf16 v[136:139], v[184:187], v[204:207], v[136:139]
    v_mfma_f32_16x16x32_bf16 v[140:143], v[188:191], v[204:207], v[140:143]
    s_waitcnt lgkmcnt(0)
    v_mfma_f32_16x16x32_bf16 v[144:147], v[220:223], v[176:179], v[144:147]
    v_mfma_f32_16x16x32_bf16 v[148:151], v[220:223], v[180:183], v[148:151]
    v_mfma_f32_16x16x32_bf16 v[152:155], v[220:223], v[184:187], v[152:155]
    v_mfma_f32_16x16x32_bf16 v[156:159], v[220:223], v[188:191], v[156:159]
    s_barrier
    s_waitcnt vmcnt(8)
    ds_read_b128 v[160:163], v228 offset:32768
    ds_read_b128 v[208:211], v232 offset:18432
    ds_read_b128 v[164:167], v228 offset:34816
    ds_read_b128 v[168:171], v228 offset:36864
    ds_read_b128 v[172:175], v228 offset:38912
    ds_read_b128 v[212:215], v232 offset:19456
    ds_read_b128 v[192:195], v232 offset:20480
    ds_read_b128 v[176:179], v229 offset:32768
    ds_read_b128 v[180:183], v229 offset:34816
    ds_read_b128 v[184:187], v229 offset:36864
    ds_read_b128 v[188:191], v229 offset:38912
    s_waitcnt lgkmcnt(9)
    v_mfma_f32_16x16x32_bf16 v[16:19], v[160:163], v[208:211], v[16:19]
    s_waitcnt lgkmcnt(8)
    v_mfma_f32_16x16x32_bf16 v[20:23], v[164:167], v[208:211], v[20:23]
    s_waitcnt lgkmcnt(7)
    v_mfma_f32_16x16x32_bf16 v[24:27], v[168:171], v[208:211], v[24:27]
    s_waitcnt lgkmcnt(6)
    v_mfma_f32_16x16x32_bf16 v[28:31], v[172:175], v[208:211], v[28:31]
    ds_read_b128 v[196:199], v232 offset:21504
    s_waitcnt lgkmcnt(6)
    v_mfma_f32_16x16x32_bf16 v[32:35], v[160:163], v[212:215], v[32:35]
    v_mfma_f32_16x16x32_bf16 v[36:39], v[164:167], v[212:215], v[36:39]
    v_mfma_f32_16x16x32_bf16 v[40:43], v[168:171], v[212:215], v[40:43]
    v_mfma_f32_16x16x32_bf16 v[44:47], v[172:175], v[212:215], v[44:47]
    ds_read_b128 v[200:203], v232 offset:22528
    s_waitcnt lgkmcnt(6)
    v_mfma_f32_16x16x32_bf16 v[48:51], v[160:163], v[192:195], v[48:51]
    v_mfma_f32_16x16x32_bf16 v[52:55], v[164:167], v[192:195], v[52:55]
    v_mfma_f32_16x16x32_bf16 v[56:59], v[168:171], v[192:195], v[56:59]
    v_mfma_f32_16x16x32_bf16 v[60:63], v[172:175], v[192:195], v[60:63]
    ds_read_b128 v[204:207], v232 offset:23552
    s_waitcnt lgkmcnt(2)
    v_mfma_f32_16x16x32_bf16 v[64:67], v[160:163], v[196:199], v[64:67]
    v_mfma_f32_16x16x32_bf16 v[68:71], v[164:167], v[196:199], v[68:71]
    v_mfma_f32_16x16x32_bf16 v[72:75], v[168:171], v[196:199], v[72:75]
    v_mfma_f32_16x16x32_bf16 v[76:79], v[172:175], v[196:199], v[76:79]
    ds_read_b128 v[208:211], v232 offset:24576
    s_waitcnt lgkmcnt(2)
    v_mfma_f32_16x16x32_bf16 v[16:19], v[176:179], v[200:203], v[16:19]
    v_mfma_f32_16x16x32_bf16 v[20:23], v[180:183], v[200:203], v[20:23]
    v_mfma_f32_16x16x32_bf16 v[24:27], v[184:187], v[200:203], v[24:27]
    v_mfma_f32_16x16x32_bf16 v[28:31], v[188:191], v[200:203], v[28:31]
    ds_read_b128 v[212:215], v232 offset:25600
    s_waitcnt lgkmcnt(2)
    v_mfma_f32_16x16x32_bf16 v[32:35], v[176:179], v[204:207], v[32:35]
    v_mfma_f32_16x16x32_bf16 v[36:39], v[180:183], v[204:207], v[36:39]
    v_mfma_f32_16x16x32_bf16 v[40:43], v[184:187], v[204:207], v[40:43]
    v_mfma_f32_16x16x32_bf16 v[44:47], v[188:191], v[204:207], v[44:47]
    s_waitcnt lgkmcnt(1)
    v_mfma_f32_16x16x32_bf16 v[48:51], v[176:179], v[208:211], v[48:51]
    v_mfma_f32_16x16x32_bf16 v[52:55], v[180:183], v[208:211], v[52:55]
    v_mfma_f32_16x16x32_bf16 v[56:59], v[184:187], v[208:211], v[56:59]
    v_mfma_f32_16x16x32_bf16 v[60:63], v[188:191], v[208:211], v[60:63]
    s_waitcnt lgkmcnt(0)
    v_mfma_f32_16x16x32_bf16 v[64:67], v[176:179], v[212:215], v[64:67]
    v_mfma_f32_16x16x32_bf16 v[68:71], v[180:183], v[212:215], v[68:71]
    v_mfma_f32_16x16x32_bf16 v[72:75], v[184:187], v[212:215], v[72:75]
    v_mfma_f32_16x16x32_bf16 v[76:79], v[188:191], v[212:215], v[76:79]
    s_barrier
    s_waitcnt vmcnt(0)
    ds_read_b128 v[160:163], v230 offset:0
    ds_read_b128 v[192:195], v232 offset:0
    ds_read_b128 v[164:167], v230 offset:2048
    ds_read_b128 v[168:171], v230 offset:4096
    ds_read_b128 v[172:175], v230 offset:6144
    ds_read_b128 v[196:199], v232 offset:1024
    ds_read_b128 v[200:203], v232 offset:2048
    ds_read_b128 v[176:179], v231 offset:0
    ds_read_b128 v[180:183], v231 offset:2048
    ds_read_b128 v[184:187], v231 offset:4096
    ds_read_b128 v[188:191], v231 offset:6144
    s_waitcnt lgkmcnt(9)
    v_mfma_f32_16x16x32_bf16 v[16:19], v[160:163], v[192:195], v[16:19]
    s_waitcnt lgkmcnt(8)
    v_mfma_f32_16x16x32_bf16 v[20:23], v[164:167], v[192:195], v[20:23]
    s_waitcnt lgkmcnt(7)
    v_mfma_f32_16x16x32_bf16 v[24:27], v[168:171], v[192:195], v[24:27]
    s_waitcnt lgkmcnt(6)
    v_mfma_f32_16x16x32_bf16 v[28:31], v[172:175], v[192:195], v[28:31]
    ds_read_b128 v[204:207], v232 offset:3072
    s_waitcnt lgkmcnt(6)
    v_mfma_f32_16x16x32_bf16 v[32:35], v[160:163], v[196:199], v[32:35]
    v_mfma_f32_16x16x32_bf16 v[36:39], v[164:167], v[196:199], v[36:39]
    v_mfma_f32_16x16x32_bf16 v[40:43], v[168:171], v[196:199], v[40:43]
    v_mfma_f32_16x16x32_bf16 v[44:47], v[172:175], v[196:199], v[44:47]
    ds_read_b128 v[208:211], v232 offset:4096
    s_waitcnt lgkmcnt(6)
    v_mfma_f32_16x16x32_bf16 v[48:51], v[160:163], v[200:203], v[48:51]
    v_mfma_f32_16x16x32_bf16 v[52:55], v[164:167], v[200:203], v[52:55]
    v_mfma_f32_16x16x32_bf16 v[56:59], v[168:171], v[200:203], v[56:59]
    v_mfma_f32_16x16x32_bf16 v[60:63], v[172:175], v[200:203], v[60:63]
    ds_read_b128 v[212:215], v232 offset:5120
    s_waitcnt lgkmcnt(2)
    v_mfma_f32_16x16x32_bf16 v[64:67], v[160:163], v[204:207], v[64:67]
    ds_read_b128 v[160:163], v228 offset:32768
    v_mfma_f32_16x16x32_bf16 v[68:71], v[164:167], v[204:207], v[68:71]
    ds_read_b128 v[164:167], v228 offset:34816
    v_mfma_f32_16x16x32_bf16 v[72:75], v[168:171], v[204:207], v[72:75]
    v_mfma_f32_16x16x32_bf16 v[76:79], v[172:175], v[204:207], v[76:79]
    ds_read_b128 v[192:195], v232 offset:6144
    s_waitcnt lgkmcnt(4)
    v_mfma_f32_16x16x32_bf16 v[16:19], v[176:179], v[208:211], v[16:19]
    v_mfma_f32_16x16x32_bf16 v[20:23], v[180:183], v[208:211], v[20:23]
    v_mfma_f32_16x16x32_bf16 v[24:27], v[184:187], v[208:211], v[24:27]
    v_mfma_f32_16x16x32_bf16 v[28:31], v[188:191], v[208:211], v[28:31]
    ds_read_b128 v[196:199], v232 offset:7168
    s_waitcnt lgkmcnt(4)
    v_mfma_f32_16x16x32_bf16 v[32:35], v[176:179], v[212:215], v[32:35]
    v_mfma_f32_16x16x32_bf16 v[36:39], v[180:183], v[212:215], v[36:39]
    ds_read_b128 v[168:171], v229 offset:32768
    v_mfma_f32_16x16x32_bf16 v[40:43], v[184:187], v[212:215], v[40:43]
    ds_read_b128 v[172:175], v229 offset:34816
    v_mfma_f32_16x16x32_bf16 v[44:47], v[188:191], v[212:215], v[44:47]
    ds_read_b128 v[200:203], v232 offset:26624
    s_waitcnt lgkmcnt(4)
    v_mfma_f32_16x16x32_bf16 v[48:51], v[176:179], v[192:195], v[48:51]
    v_mfma_f32_16x16x32_bf16 v[52:55], v[180:183], v[192:195], v[52:55]
    ds_read_b128 v[204:207], v232 offset:27648
    v_mfma_f32_16x16x32_bf16 v[56:59], v[184:187], v[192:195], v[56:59]
    v_mfma_f32_16x16x32_bf16 v[60:63], v[188:191], v[192:195], v[60:63]
    ds_read_b128 v[208:211], v232 offset:28672
    s_waitcnt lgkmcnt(5)
    v_mfma_f32_16x16x32_bf16 v[64:67], v[176:179], v[196:199], v[64:67]
    v_mfma_f32_16x16x32_bf16 v[68:71], v[180:183], v[196:199], v[68:71]
    ds_read_b128 v[212:215], v232 offset:29696
    v_mfma_f32_16x16x32_bf16 v[72:75], v[184:187], v[196:199], v[72:75]
    v_mfma_f32_16x16x32_bf16 v[76:79], v[188:191], v[196:199], v[76:79]
    ds_read_b128 v[216:219], v232 offset:34816
    ds_read_b128 v[176:179], v230 offset:0
    s_waitcnt lgkmcnt(5)
    v_mfma_f32_16x16x32_bf16 v[80:83], v[160:163], v[200:203], v[80:83]
    ds_read_b128 v[180:183], v230 offset:2048
    v_mfma_f32_16x16x32_bf16 v[84:87], v[164:167], v[200:203], v[84:87]
    ds_read_b128 v[192:195], v232 offset:30720
    s_waitcnt lgkmcnt(6)
    v_mfma_f32_16x16x32_bf16 v[96:99], v[160:163], v[204:207], v[96:99]
    v_mfma_f32_16x16x32_bf16 v[100:103], v[164:167], v[204:207], v[100:103]
    v_cvt_pk_bf16_f32 v236, v16, v32
    v_cvt_pk_bf16_f32 v237, v48, v64
    buffer_store_dwordx2 v[236:237], v233, s[24:27], s48 offen sc1
    ds_read_b128 v[196:199], v232 offset:31744
    s_waitcnt lgkmcnt(6)
    v_mfma_f32_16x16x32_bf16 v[112:115], v[160:163], v[208:211], v[112:115]
    v_mfma_f32_16x16x32_bf16 v[116:119], v[164:167], v[208:211], v[116:119]
    ds_read_b128 v[200:203], v232 offset:32768
    s_waitcnt lgkmcnt(6)
    v_mfma_f32_16x16x32_bf16 v[128:131], v[160:163], v[212:215], v[128:131]
    v_cvt_pk_bf16_f32 v238, v17, v33
    v_cvt_pk_bf16_f32 v239, v49, v65
    buffer_store_dwordx2 v[238:239], v233, s[24:27], s49 offen sc1
    v_mfma_f32_16x16x32_bf16 v[132:135], v[164:167], v[212:215], v[132:135]
    ds_read_b128 v[204:207], v232 offset:33792
    s_waitcnt lgkmcnt(6)
    v_mfma_f32_16x16x32_bf16 v[144:147], v[216:219], v[160:163], v[144:147]
    v_mfma_f32_16x16x32_bf16 v[148:151], v[216:219], v[164:167], v[148:151]
    ds_read_b128 v[220:223], v232 offset:35840
    ds_read_b128 v[184:187], v231 offset:0
    s_waitcnt lgkmcnt(5)
    v_mfma_f32_16x16x32_bf16 v[80:83], v[168:171], v[192:195], v[80:83]
    v_cvt_pk_bf16_f32 v240, v18, v34
    v_cvt_pk_bf16_f32 v241, v50, v66
    buffer_store_dwordx2 v[240:241], v233, s[24:27], s50 offen sc1
    ds_read_b128 v[188:191], v231 offset:2048
    v_mfma_f32_16x16x32_bf16 v[84:87], v[172:175], v[192:195], v[84:87]
    ds_read_b128 v[208:211], v232 offset:8192
    s_waitcnt lgkmcnt(6)
    v_mfma_f32_16x16x32_bf16 v[96:99], v[168:171], v[196:199], v[96:99]
    v_mfma_f32_16x16x32_bf16 v[100:103], v[172:175], v[196:199], v[100:103]
    v_cvt_pk_bf16_f32 v242, v19, v35
    v_cvt_pk_bf16_f32 v243, v51, v67
    buffer_store_dwordx2 v[242:243], v233, s[24:27], s51 offen sc1
    ds_read_b128 v[212:215], v232 offset:9216
    s_waitcnt lgkmcnt(6)
    v_mfma_f32_16x16x32_bf16 v[112:115], v[168:171], v[200:203], v[112:115]
    v_mfma_f32_16x16x32_bf16 v[116:119], v[172:175], v[200:203], v[116:119]
    ds_read_b128 v[192:195], v232 offset:10240
    s_waitcnt lgkmcnt(6)
    v_mfma_f32_16x16x32_bf16 v[128:131], v[168:171], v[204:207], v[128:131]
    v_mfma_f32_16x16x32_bf16 v[132:135], v[172:175], v[204:207], v[132:135]
    v_cvt_pk_bf16_f32 v236, v20, v36
    v_cvt_pk_bf16_f32 v237, v52, v68
    buffer_store_dwordx2 v[236:237], v233, s[24:27], s52 offen sc1
    ds_read_b128 v[196:199], v232 offset:11264
    s_waitcnt lgkmcnt(6)
    v_mfma_f32_16x16x32_bf16 v[144:147], v[220:223], v[168:171], v[144:147]
    v_mfma_f32_16x16x32_bf16 v[148:151], v[220:223], v[172:175], v[148:151]
    ds_read_b128 v[216:219], v232 offset:16384
    ds_read_b128 v[160:163], v228 offset:36864
    s_waitcnt lgkmcnt(5)
    v_mfma_f32_16x16x32_bf16 v[80:83], v[176:179], v[208:211], v[80:83]
    v_cvt_pk_bf16_f32 v238, v21, v37
    v_cvt_pk_bf16_f32 v239, v53, v69
    buffer_store_dwordx2 v[238:239], v233, s[24:27], s53 offen sc1
    ds_read_b128 v[164:167], v228 offset:38912
    v_mfma_f32_16x16x32_bf16 v[84:87], v[180:183], v[208:211], v[84:87]
    ds_read_b128 v[200:203], v232 offset:12288
    s_waitcnt lgkmcnt(6)
    v_mfma_f32_16x16x32_bf16 v[96:99], v[176:179], v[212:215], v[96:99]
    v_mfma_f32_16x16x32_bf16 v[100:103], v[180:183], v[212:215], v[100:103]
    ds_read_b128 v[204:207], v232 offset:13312
    s_waitcnt lgkmcnt(6)
    v_mfma_f32_16x16x32_bf16 v[112:115], v[176:179], v[192:195], v[112:115]
    v_cvt_pk_bf16_f32 v240, v22, v38
    v_cvt_pk_bf16_f32 v241, v54, v70
    buffer_store_dwordx2 v[240:241], v233, s[24:27], s54 offen sc1
    v_mfma_f32_16x16x32_bf16 v[116:119], v[180:183], v[192:195], v[116:119]
    ds_read_b128 v[208:211], v232 offset:14336
    s_waitcnt lgkmcnt(6)
    v_mfma_f32_16x16x32_bf16 v[128:131], v[176:179], v[196:199], v[128:131]
    v_mfma_f32_16x16x32_bf16 v[132:135], v[180:183], v[196:199], v[132:135]
    v_cvt_pk_bf16_f32 v242, v23, v39
    v_cvt_pk_bf16_f32 v243, v55, v71
    buffer_store_dwordx2 v[242:243], v233, s[24:27], s55 offen sc1
    ds_read_b128 v[212:215], v232 offset:15360
    s_waitcnt lgkmcnt(6)
    v_mfma_f32_16x16x32_bf16 v[144:147], v[216:219], v[176:179], v[144:147]
    v_mfma_f32_16x16x32_bf16 v[148:151], v[216:219], v[180:183], v[148:151]
    ds_read_b128 v[220:223], v232 offset:17408
    ds_read_b128 v[168:171], v229 offset:36864
    s_waitcnt lgkmcnt(5)
    v_mfma_f32_16x16x32_bf16 v[80:83], v[184:187], v[200:203], v[80:83]
    ds_read_b128 v[172:175], v229 offset:38912
    v_mfma_f32_16x16x32_bf16 v[84:87], v[188:191], v[200:203], v[84:87]
    v_cvt_pk_bf16_f32 v236, v24, v40
    v_cvt_pk_bf16_f32 v237, v56, v72
    buffer_store_dwordx2 v[236:237], v233, s[24:27], s56 offen sc1
    ds_read_b128 v[192:195], v232 offset:26624
    s_waitcnt lgkmcnt(6)
    v_mfma_f32_16x16x32_bf16 v[96:99], v[184:187], v[204:207], v[96:99]
    v_mfma_f32_16x16x32_bf16 v[100:103], v[188:191], v[204:207], v[100:103]
    ds_read_b128 v[196:199], v232 offset:27648
    s_waitcnt lgkmcnt(6)
    v_mfma_f32_16x16x32_bf16 v[112:115], v[184:187], v[208:211], v[112:115]
    v_cvt_pk_bf16_f32 v238, v25, v41
    v_cvt_pk_bf16_f32 v239, v57, v73
    buffer_store_dwordx2 v[238:239], v233, s[24:27], s57 offen sc1
    v_mfma_f32_16x16x32_bf16 v[116:119], v[188:191], v[208:211], v[116:119]
    ds_read_b128 v[200:203], v232 offset:28672
    s_waitcnt lgkmcnt(6)
    v_mfma_f32_16x16x32_bf16 v[128:131], v[184:187], v[212:215], v[128:131]
    v_mfma_f32_16x16x32_bf16 v[132:135], v[188:191], v[212:215], v[132:135]
    ds_read_b128 v[204:207], v232 offset:29696
    s_waitcnt lgkmcnt(6)
    v_mfma_f32_16x16x32_bf16 v[144:147], v[220:223], v[184:187], v[144:147]
    v_cvt_pk_bf16_f32 v240, v26, v42
    v_cvt_pk_bf16_f32 v241, v58, v74
    buffer_store_dwordx2 v[240:241], v233, s[24:27], s58 offen sc1
    v_mfma_f32_16x16x32_bf16 v[148:151], v[220:223], v[188:191], v[148:151]
    ds_read_b128 v[216:219], v232 offset:34816
    ds_read_b128 v[176:179], v230 offset:4096
    s_waitcnt lgkmcnt(5)
    v_mfma_f32_16x16x32_bf16 v[88:91], v[160:163], v[192:195], v[88:91]
    ds_read_b128 v[180:183], v230 offset:6144
    v_mfma_f32_16x16x32_bf16 v[92:95], v[164:167], v[192:195], v[92:95]
    v_cvt_pk_bf16_f32 v242, v27, v43
    v_cvt_pk_bf16_f32 v243, v59, v75
    buffer_store_dwordx2 v[242:243], v233, s[24:27], s59 offen sc1
    ds_read_b128 v[208:211], v232 offset:30720
    s_waitcnt lgkmcnt(6)
    v_mfma_f32_16x16x32_bf16 v[104:107], v[160:163], v[196:199], v[104:107]
    v_mfma_f32_16x16x32_bf16 v[108:111], v[164:167], v[196:199], v[108:111]
    ds_read_b128 v[212:215], v232 offset:31744
    s_waitcnt lgkmcnt(6)
    v_mfma_f32_16x16x32_bf16 v[120:123], v[160:163], v[200:203], v[120:123]
    v_mfma_f32_16x16x32_bf16 v[124:127], v[164:167], v[200:203], v[124:127]
    v_cvt_pk_bf16_f32 v236, v28, v44
    v_cvt_pk_bf16_f32 v237, v60, v76
    buffer_store_dwordx2 v[236:237], v233, s[24:27], s60 offen sc1
    ds_read_b128 v[192:195], v232 offset:32768
    s_waitcnt lgkmcnt(6)
    v_mfma_f32_16x16x32_bf16 v[136:139], v[160:163], v[204:207], v[136:139]
    v_mfma_f32_16x16x32_bf16 v[140:143], v[164:167], v[204:207], v[140:143]
    ds_read_b128 v[196:199], v232 offset:33792
    s_waitcnt lgkmcnt(6)
    v_mfma_f32_16x16x32_bf16 v[152:155], v[216:219], v[160:163], v[152:155]
    v_cvt_pk_bf16_f32 v238, v29, v45
    v_cvt_pk_bf16_f32 v239, v61, v77
    buffer_store_dwordx2 v[238:239], v233, s[24:27], s61 offen sc1
    v_mfma_f32_16x16x32_bf16 v[156:159], v[216:219], v[164:167], v[156:159]
    ds_read_b128 v[220:223], v232 offset:35840
    ds_read_b128 v[184:187], v231 offset:4096
    s_waitcnt lgkmcnt(5)
    v_mfma_f32_16x16x32_bf16 v[88:91], v[168:171], v[208:211], v[88:91]
    ds_read_b128 v[188:191], v231 offset:6144
    v_mfma_f32_16x16x32_bf16 v[92:95], v[172:175], v[208:211], v[92:95]
    ds_read_b128 v[200:203], v232 offset:8192
    s_waitcnt lgkmcnt(6)
    v_mfma_f32_16x16x32_bf16 v[104:107], v[168:171], v[212:215], v[104:107]
    v_cvt_pk_bf16_f32 v240, v30, v46
    v_cvt_pk_bf16_f32 v241, v62, v78
    buffer_store_dwordx2 v[240:241], v233, s[24:27], s62 offen sc1
    v_mfma_f32_16x16x32_bf16 v[108:111], v[172:175], v[212:215], v[108:111]
    ds_read_b128 v[204:207], v232 offset:9216
    s_waitcnt lgkmcnt(6)
    v_mfma_f32_16x16x32_bf16 v[120:123], v[168:171], v[192:195], v[120:123]
    v_mfma_f32_16x16x32_bf16 v[124:127], v[172:175], v[192:195], v[124:127]
    v_cvt_pk_bf16_f32 v242, v31, v47
    v_cvt_pk_bf16_f32 v243, v63, v79
    buffer_store_dwordx2 v[242:243], v233, s[24:27], s63 offen sc1
    ds_read_b128 v[208:211], v232 offset:10240
    s_waitcnt lgkmcnt(6)
    v_mfma_f32_16x16x32_bf16 v[136:139], v[168:171], v[196:199], v[136:139]
    v_mfma_f32_16x16x32_bf16 v[140:143], v[172:175], v[196:199], v[140:143]
    ds_read_b128 v[212:215], v232 offset:11264
    s_waitcnt lgkmcnt(6)
    v_mfma_f32_16x16x32_bf16 v[152:155], v[220:223], v[168:171], v[152:155]
    v_mfma_f32_16x16x32_bf16 v[156:159], v[220:223], v[172:175], v[156:159]
    v_cvt_pk_bf16_f32 v236, v80, v96
    v_cvt_pk_bf16_f32 v237, v112, v128
    buffer_store_dwordx2 v[236:237], v233, s[24:27], s48 offen offset:128 sc1
    ds_read_b128 v[216:219], v232 offset:16384
    s_waitcnt lgkmcnt(4)
    v_mfma_f32_16x16x32_bf16 v[88:91], v[176:179], v[200:203], v[88:91]
    v_mfma_f32_16x16x32_bf16 v[92:95], v[180:183], v[200:203], v[92:95]
    ds_read_b128 v[192:195], v232 offset:12288
    s_waitcnt lgkmcnt(4)
    v_mfma_f32_16x16x32_bf16 v[104:107], v[176:179], v[204:207], v[104:107]
    v_cvt_pk_bf16_f32 v238, v81, v97
    v_cvt_pk_bf16_f32 v239, v113, v129
    buffer_store_dwordx2 v[238:239], v233, s[24:27], s49 offen offset:128 sc1
    v_mfma_f32_16x16x32_bf16 v[108:111], v[180:183], v[204:207], v[108:111]
    ds_read_b128 v[196:199], v232 offset:13312
    s_waitcnt lgkmcnt(4)
    v_mfma_f32_16x16x32_bf16 v[120:123], v[176:179], v[208:211], v[120:123]
    v_mfma_f32_16x16x32_bf16 v[124:127], v[180:183], v[208:211], v[124:127]
    ds_read_b128 v[200:203], v232 offset:14336
    s_waitcnt lgkmcnt(4)
    v_mfma_f32_16x16x32_bf16 v[136:139], v[176:179], v[212:215], v[136:139]
    v_cvt_pk_bf16_f32 v240, v82, v98
    v_cvt_pk_bf16_f32 v241, v114, v130
    buffer_store_dwordx2 v[240:241], v233, s[24:27], s50 offen offset:128 sc1
    v_mfma_f32_16x16x32_bf16 v[140:143], v[180:183], v[212:215], v[140:143]
    ds_read_b128 v[204:207], v232 offset:15360
    s_waitcnt lgkmcnt(4)
    v_mfma_f32_16x16x32_bf16 v[152:155], v[216:219], v[176:179], v[152:155]
    v_mfma_f32_16x16x32_bf16 v[156:159], v[216:219], v[180:183], v[156:159]
    v_cvt_pk_bf16_f32 v242, v83, v99
    v_cvt_pk_bf16_f32 v243, v115, v131
    buffer_store_dwordx2 v[242:243], v233, s[24:27], s51 offen offset:128 sc1
    ds_read_b128 v[220:223], v232 offset:17408
    s_waitcnt lgkmcnt(4)
    v_mfma_f32_16x16x32_bf16 v[88:91], v[184:187], v[192:195], v[88:91]
    v_mfma_f32_16x16x32_bf16 v[92:95], v[188:191], v[192:195], v[92:95]
    s_waitcnt lgkmcnt(3)
    v_mfma_f32_16x16x32_bf16 v[104:107], v[184:187], v[196:199], v[104:107]
    v_mfma_f32_16x16x32_bf16 v[108:111], v[188:191], v[196:199], v[108:111]
    v_cvt_pk_bf16_f32 v236, v84, v100
    v_cvt_pk_bf16_f32 v237, v116, v132
    buffer_store_dwordx2 v[236:237], v233, s[24:27], s52 offen offset:128 sc1
    s_waitcnt lgkmcnt(2)
    v_mfma_f32_16x16x32_bf16 v[120:123], v[184:187], v[200:203], v[120:123]
    v_mfma_f32_16x16x32_bf16 v[124:127], v[188:191], v[200:203], v[124:127]
    s_waitcnt lgkmcnt(1)
    v_mfma_f32_16x16x32_bf16 v[136:139], v[184:187], v[204:207], v[136:139]
    v_cvt_pk_bf16_f32 v238, v85, v101
    v_cvt_pk_bf16_f32 v239, v117, v133
    buffer_store_dwordx2 v[238:239], v233, s[24:27], s53 offen offset:128 sc1
    v_mfma_f32_16x16x32_bf16 v[140:143], v[188:191], v[204:207], v[140:143]
    s_waitcnt lgkmcnt(0)
    v_mfma_f32_16x16x32_bf16 v[152:155], v[220:223], v[184:187], v[152:155]
    v_mfma_f32_16x16x32_bf16 v[156:159], v[220:223], v[188:191], v[156:159]
    v_cvt_pk_bf16_f32 v240, v86, v102
    v_cvt_pk_bf16_f32 v241, v118, v134
    buffer_store_dwordx2 v[240:241], v233, s[24:27], s54 offen offset:128 sc1
    v_cvt_pk_bf16_f32 v242, v87, v103
    v_cvt_pk_bf16_f32 v243, v119, v135
    buffer_store_dwordx2 v[242:243], v233, s[24:27], s55 offen offset:128 sc1
    v_cvt_pk_bf16_f32 v144, v144, v145
    v_cvt_pk_bf16_f32 v145, v146, v147
    buffer_store_dwordx2 v[144:145], v234, s[24:27], 0 offen
    v_cvt_pk_bf16_f32 v148, v148, v149
    v_cvt_pk_bf16_f32 v149, v150, v151
    buffer_store_dwordx2 v[148:149], v234, s[24:27], s52 offen
    v_cvt_pk_bf16_f32 v236, v88, v104
    v_cvt_pk_bf16_f32 v237, v120, v136
    buffer_store_dwordx2 v[236:237], v233, s[24:27], s56 offen offset:128 sc1
    v_cvt_pk_bf16_f32 v238, v89, v105
    v_cvt_pk_bf16_f32 v239, v121, v137
    buffer_store_dwordx2 v[238:239], v233, s[24:27], s57 offen offset:128 sc1
    v_cvt_pk_bf16_f32 v240, v90, v106
    v_cvt_pk_bf16_f32 v241, v122, v138
    buffer_store_dwordx2 v[240:241], v233, s[24:27], s58 offen offset:128 sc1
    v_cvt_pk_bf16_f32 v242, v91, v107
    v_cvt_pk_bf16_f32 v243, v123, v139
    buffer_store_dwordx2 v[242:243], v233, s[24:27], s59 offen offset:128 sc1
    v_cvt_pk_bf16_f32 v236, v92, v108
    v_cvt_pk_bf16_f32 v237, v124, v140
    buffer_store_dwordx2 v[236:237], v233, s[24:27], s60 offen offset:128 sc1
    v_cvt_pk_bf16_f32 v238, v93, v109
    v_cvt_pk_bf16_f32 v239, v125, v141
    buffer_store_dwordx2 v[238:239], v233, s[24:27], s61 offen offset:128 sc1
    v_cvt_pk_bf16_f32 v240, v94, v110
    v_cvt_pk_bf16_f32 v241, v126, v142
    buffer_store_dwordx2 v[240:241], v233, s[24:27], s62 offen offset:128 sc1
    v_cvt_pk_bf16_f32 v242, v95, v111
    v_cvt_pk_bf16_f32 v243, v127, v143
    buffer_store_dwordx2 v[242:243], v233, s[24:27], s63 offen offset:128 sc1
    v_cvt_pk_bf16_f32 v152, v152, v153
    v_cvt_pk_bf16_f32 v153, v154, v155
    buffer_store_dwordx2 v[152:153], v234, s[24:27], s56 offen
    v_cvt_pk_bf16_f32 v156, v156, v157
    v_cvt_pk_bf16_f32 v157, v158, v159
    buffer_store_dwordx2 v[156:157], v234, s[24:27], s60 offen
    s_endpgm
L_done:
    s_endpgm
.section .rodata,"a"
.p2align 6
.amdhsa_kernel standalone__weight_only_int_quip_2__prompt_kernel
  .amdhsa_next_free_vgpr 256
  .amdhsa_next_free_sgpr 102
  .amdhsa_accum_offset 256
  .amdhsa_group_segment_fixed_size 0
  .amdhsa_kernarg_size 56
  .amdhsa_user_sgpr_count 2
  .amdhsa_user_sgpr_kernarg_segment_ptr 1
  .amdhsa_system_sgpr_workgroup_id_x 1
  .amdhsa_float_denorm_mode_32 3
.end_amdhsa_kernel
```
